```python
import torch

def _softmax(x, axis=-1):
    return torch.softmax(x, dim=axis)
def _gelu(x):
    return torch.nn.functional.gelu(x, approximate="tanh")
def _silu(x):
    return torch.nn.functional.silu(x)
def _sigmoid(x):
    return torch.sigmoid(x)
def _layernorm(x, axis=-1, eps=1e-5):
    m = x.mean(dim=axis, keepdim=True)
    v = x.var(dim=axis, keepdim=True, unbiased=False)
    return (x - m) / torch.sqrt(v + eps)
def _scatter_add(tgt, idx, src, axis=0):
    return tgt.clone().index_add_(axis, idx, src)
def _segment_sum(src, seg, n):
    out = torch.zeros((n,) + src.shape[1:], dtype=src.dtype)
    return out.index_add_(0, seg, src)
def _pad(x, pw):
    flat = tuple(v for pair in reversed(pw) for v in pair)
    return torch.nn.functional.pad(x, flat)

kernel_name = 'gated_mix__spectral_gfnet__dense_activation_gelu__prompt'

def setup_inputs():

    _w = (lambda a: (lambda t: t.to(torch.bfloat16) if t.is_floating_point() else t)(torch.as_tensor(a)))
    def _A_setup():
        B, S, D = 1, 2048, 1024
        Df = D // 2 + 1
        return {
            "x": _w((lambda *s: torch.randn(*s, dtype=torch.bfloat16) * 0.05)(B, S, D)),
            "w_r": _w((lambda *s: torch.randn(*s, dtype=torch.bfloat16) * 3.2)(S, Df) * 0.02),
            "w_i": _w((lambda *s: torch.randn(*s, dtype=torch.bfloat16) * 3.2)(S, Df) * 0.02),
        }
    _A_in = _A_setup()

    def _B_setup():
        B, S, D, F = 1, 2048, 1024, 3584
        return {
            "x": _w((lambda *s: torch.randn(*s, dtype=torch.bfloat16) * 0.05)(B, S, D)),
            "w1": _w((lambda *s: torch.randn(*s, dtype=torch.bfloat16) * 3.2)(D, F) * (D ** -0.5)),
            "b1": _w((lambda *s: torch.randn(*s, dtype=torch.bfloat16) * 3.2)(F) * 0.01),
            "w2": _w((lambda *s: torch.randn(*s, dtype=torch.bfloat16) * 0.2)(F, D) * (F ** -0.5)),
            "b2": _w((lambda *s: torch.randn(*s, dtype=torch.bfloat16) * 0.4)(D) * 0.01),
        }
    _B_in = _B_setup()

    return {
        "A_x": _A_in["x"],
        "A_w_r": _A_in["w_r"],
        "A_w_i": _A_in["w_i"],
        "B_x": _B_in["x"],
        "B_w1": _B_in["w1"],
        "B_b1": _B_in["b1"],
        "B_w2": _B_in["w2"],
        "B_b2": _B_in["b2"],
        "gate_w": _w((lambda *s: torch.randn(*s, dtype=torch.bfloat16) * 0.05)(1024) * 16.0),
    }

def reference(A_x, A_w_r, A_w_i, B_x, B_w1, B_b1, B_w2, B_b2, gate_w):
    def _A_ref(x, w_r, w_i):
        B, S, D = x.shape
        X = (lambda x, axes=(-2,-1): torch.fft.rfft2(x.float(), dim=axes))(x, axes=(-2, -1))
        W = w_r + 1j * w_i
        X = X * W
        y = (lambda x, s, axes=(-2,-1): torch.fft.irfft2(x, s=s, dim=axes).to(torch.bfloat16))(X, (S, D), axes=(-2, -1))
        return y

    def _B_ref(x, w1, b1, w2, b2):
        h = torch.einsum("bsd,df->bsf", x, w1) + b1
        h = _gelu(h)
        return torch.einsum("bsf,fd->bsd", h, w2) + b2

    x = A_x
    g = _sigmoid((x * gate_w).sum(-1, keepdims=True))
    a = _A_ref(x, A_w_r, A_w_i)
    b = _B_ref(x, B_w1, B_b1, B_w2, B_b2)
    return g * a + (1 - g) * b
```

```asm
; @launch grid=(256,1,1) block=(512,1,1) lds=163840
.amdgcn_target "amdgcn-amd-amdhsa--gfx950"
.text
.globl gated_mix__spectral_gfnet__dense_activation_gelu__prompt_kernel
.p2align 8
.type gated_mix__spectral_gfnet__dense_activation_gelu__prompt_kernel,@function
gated_mix__spectral_gfnet__dense_activation_gelu__prompt_kernel:
    s_cmp_ge_u32 s2, 256
    s_cbranch_scc1 Lend_1
    s_load_dwordx16 s[32:47], s[0:1], 0
    s_load_dwordx8 s[48:55], s[0:1], 64
    s_lshr_b32 s3, s2, 3
    s_xor_b32 s3, s3, s2
    s_and_b32 s3, s3, 1
    s_lshl_b32 s4, s3, 3
    s_or_b32 s3, s3, s4
    s_xor_b32 s2, s2, s3

    v_lshrrev_b32 v2, 6, v0
    v_and_b32 v1, 63, v0
    v_readfirstlane_b32 s19, v2
    v_and_b32 v2, 15, v1
    v_lshlrev_b32 v2, 2, v2
    v_add_u32 v2, 151552, v2
    v_mov_b32 v3, 0
    ds_write_b32 v2, v3
    s_and_b32 s28, s19, 3
    s_lshr_b32 s69, s19, 2
    s_and_b32 s68, s2, 0xfe
    s_xor_b32 s3, s69, 1
    s_add_u32 s68, s68, s3

    s_and_b32 s78, s2, 1
    s_lshl_b32 s78, s78, 3
    s_bfe_u32 s79, s2, 0x30003
    s_add_u32 s78, s78, s79
    s_lshl_b32 s29, s78, 7
    s_bfe_u32 s78, s2, 0x20001
    s_lshl_b32 s78, s78, 2
    s_lshr_b32 s79, s2, 6
    s_add_u32 s83, s78, s79
    s_mul_i32 s30, s83, 224
    s_mov_b32 s31, 0

    s_lshr_b32 s3, s29, 6
    s_lshr_b32 s4, s83, 3
    s_add_u32 s3, s3, s4
    s_lshl_b32 s3, s3, 7
    s_add_u32 s82, s3, 49283072
    s_and_b32 s5, s83, 7
    s_lshl_b32 s6, s5, 2
    s_add_u32 s100, s82, s6
    s_lshl_b32 s5, s5, 1
    s_add_u32 s5, s5, s4
    s_lshl_b32 s5, s5, 2
    s_add_u32 s5, s5, s28
    s_lshl_b32 s5, s5, 2
    s_lshl_b32 s6, s29, 1
    s_add_u32 s5, s5, s6
    s_add_u32 s101, s5, 49291264
    s_waitcnt lgkmcnt(0)

    s_lshl_b32 s5, s2, 7
    s_lshl_b32 s6, s28, 2
    s_add_u32 s5, s5, s6
    s_add_u32 s101, s5, 49291264
    s_mov_b32 s56, s54
    s_mov_b32 s57, s55
    s_mov_b32 s58, 50331648
    s_mov_b32 s59, 0x20000
    s_barrier
    s_cmp_eq_u32 s69, 0
    s_cbranch_scc1 Ls0_4
    s_mov_b32 s8, s32
    s_mov_b32 s9, s33
    s_mov_b32 s10, 4194304
    s_mov_b32 s11, 0x20000
    s_mov_b32 s12, s40
    s_mov_b32 s13, s41
    s_mov_b32 s14, 7340032
    s_mov_b32 s15, 0x20000
    s_mul_i32 s70, s28, 32
    s_add_u32 s70, s70, s29
    s_mul_i32 s70, s70, 2048
    s_lshl_b32 s71, s31, 1
    s_add_u32 s70, s70, s71
    s_mov_b32 s72, 2048
    v_lshrrev_b32 v13, 3, v1
    v_mul_lo_u32 v14, v13, s72
    v_add_u32 v14, s70, v14
    v_lshrrev_b32 v15, 4, v1
    v_xor_b32 v15, v15, v1
    v_and_b32 v15, 7, v15
    v_lshlrev_b32 v15, 4, v15
    v_add_u32 v2, v14, v15
    v_lshrrev_b32 v15, 4, v1
    v_add_u32 v15, 4, v15
    v_xor_b32 v15, v15, v1
    v_and_b32 v15, 7, v15
    v_lshlrev_b32 v15, 4, v15
    v_add_u32 v3, v14, v15
    v_add_u32 v3, 15360, v3
    v_lshrrev_b32 v15, 4, v1
    v_xor_b32 v15, v15, v1
    v_and_b32 v15, 7, v15
    v_lshlrev_b32 v15, 4, v15
    v_add_u32 v4, v14, v15
    v_add_u32 v4, 30720, v4
    v_lshrrev_b32 v15, 4, v1
    v_add_u32 v15, 4, v15
    v_xor_b32 v15, v15, v1
    v_and_b32 v15, 7, v15
    v_lshlrev_b32 v15, 4, v15
    v_add_u32 v5, v14, v15
    v_add_u32 v5, 46080, v5
    s_lshl_b32 s70, s28, 4
    s_add_u32 s70, s70, s31
    s_mul_i32 s70, s70, 7168
    s_lshl_b32 s71, s30, 1
    s_add_u32 s70, s70, s71
    s_mov_b32 s72, 7168
    v_add_u32 v13, 0, v1
    v_mul_u32_u24 v14, 2341, v13
    v_lshrrev_b32 v14, 16, v14
    v_mul_u32_u24 v15, 28, v14
    v_sub_u32 v13, v13, v15
    v_lshrrev_b32 v15, 2, v14
    v_and_b32 v15, 2, v15
    v_xor_b32 v13, v13, v15
    v_lshlrev_b32 v13, 4, v13
    v_mul_lo_u32 v14, v14, s72
    v_add3_u32 v6, v13, v14, s70
    v_add_u32 v13, 64, v1
    v_mul_u32_u24 v14, 2341, v13
    v_lshrrev_b32 v14, 16, v14
    v_mul_u32_u24 v15, 28, v14
    v_sub_u32 v13, v13, v15
    v_lshrrev_b32 v15, 2, v14
    v_and_b32 v15, 2, v15
    v_xor_b32 v13, v13, v15
    v_lshlrev_b32 v13, 4, v13
    v_mul_lo_u32 v14, v14, s72
    v_add3_u32 v7, v13, v14, s70
    v_subrev_u32 v7, 1024, v7
    v_add_u32 v13, 128, v1
    v_mul_u32_u24 v14, 2341, v13
    v_lshrrev_b32 v14, 16, v14
    v_mul_u32_u24 v15, 28, v14
    v_sub_u32 v13, v13, v15
    v_lshrrev_b32 v15, 2, v14
    v_and_b32 v15, 2, v15
    v_xor_b32 v13, v13, v15
    v_lshlrev_b32 v13, 4, v13
    v_mul_lo_u32 v14, v14, s72
    v_add3_u32 v8, v13, v14, s70
    v_subrev_u32 v8, 2048, v8
    v_add_u32 v13, 192, v1
    v_mul_u32_u24 v14, 2341, v13
    v_lshrrev_b32 v14, 16, v14
    v_mul_u32_u24 v15, 28, v14
    v_sub_u32 v13, v13, v15
    v_lshrrev_b32 v15, 2, v14
    v_and_b32 v15, 2, v15
    v_xor_b32 v13, v13, v15
    v_lshlrev_b32 v13, 4, v13
    v_mul_lo_u32 v14, v14, s72
    v_add3_u32 v9, v13, v14, s70
    v_subrev_u32 v9, 3072, v9
    v_add_u32 v13, 256, v1
    v_mul_u32_u24 v14, 2341, v13
    v_lshrrev_b32 v14, 16, v14
    v_mul_u32_u24 v15, 28, v14
    v_sub_u32 v13, v13, v15
    v_lshrrev_b32 v15, 2, v14
    v_and_b32 v15, 2, v15
    v_xor_b32 v13, v13, v15
    v_lshlrev_b32 v13, 4, v13
    v_mul_lo_u32 v14, v14, s72
    v_add3_u32 v10, v13, v14, s70
    v_add_u32 v13, 320, v1
    v_mul_u32_u24 v14, 2341, v13
    v_lshrrev_b32 v14, 16, v14
    v_mul_u32_u24 v15, 28, v14
    v_sub_u32 v13, v13, v15
    v_lshrrev_b32 v15, 2, v14
    v_and_b32 v15, 2, v15
    v_xor_b32 v13, v13, v15
    v_lshlrev_b32 v13, 4, v13
    v_mul_lo_u32 v14, v14, s72
    v_add3_u32 v11, v13, v14, s70
    v_subrev_u32 v11, 1024, v11
    v_add_u32 v13, 384, v1
    v_mul_u32_u24 v14, 2341, v13
    v_lshrrev_b32 v14, 16, v14
    v_mul_u32_u24 v15, 28, v14
    v_sub_u32 v13, v13, v15
    v_lshrrev_b32 v15, 2, v14
    v_and_b32 v15, 2, v15
    v_xor_b32 v13, v13, v15
    v_lshlrev_b32 v13, 4, v13
    v_mul_lo_u32 v14, v14, s72
    v_add3_u32 v12, v13, v14, s70
    v_subrev_u32 v12, 2048, v12
    s_mul_i32 s74, s28, 4096
    s_mul_i32 s75, s28, 7168
    s_add_u32 s75, s75, 16384
    s_mov_b32 s16, 0
    s_mov_b32 s17, 0
    s_mov_b32 s18, 0
    s_add_u32 m0, s18, s74
    s_nop 0
    buffer_load_dwordx4 v2, s[8:11], s16 offen offset:0 lds
    buffer_load_dwordx4 v3, s[8:11], s16 offen offset:1024 lds
    buffer_load_dwordx4 v4, s[8:11], s16 offen offset:2048 lds
    buffer_load_dwordx4 v5, s[8:11], s16 offen offset:3072 lds
    s_add_u32 m0, s18, s75
    s_nop 0
    buffer_load_dwordx4 v6, s[12:15], s17 offen offset:0 lds
    buffer_load_dwordx4 v7, s[12:15], s17 offen offset:1024 lds
    buffer_load_dwordx4 v8, s[12:15], s17 offen offset:2048 lds
    buffer_load_dwordx4 v9, s[12:15], s17 offen offset:3072 lds
    s_add_u32 m0, m0, 4096
    s_nop 0
    buffer_load_dwordx4 v10, s[12:15], s17 offen offset:0 lds
    buffer_load_dwordx4 v11, s[12:15], s17 offen offset:1024 lds
    buffer_load_dwordx4 v12, s[12:15], s17 offen offset:2048 lds
    s_add_u32 s16, s16, 128
    s_add_u32 s17, s17, 458752
    s_add_u32 s18, s18, 45056
    s_cmp_eq_u32 s18, 135168
    s_cselect_b32 s18, 0, s18
Ls0_4:
    s_bitcmp1_b32 s2, 0
    s_cbranch_scc0 LnoRF_3
    s_cmp_lg_u32 s69, 0
    s_cbranch_scc1 Lgrp1_6
    s_mov_b32 s60, s32
    s_mov_b32 s61, s33
    s_mov_b32 s62, 4194304
    s_mov_b32 s63, 0x20000
    s_mov_b32 s64, s48
    s_mov_b32 s65, s49
    s_mov_b32 s66, 2048
    s_mov_b32 s67, 0x20000
    s_lshr_b32 s3, s68, 4
    s_lshl_b32 s3, s3, 7
    s_and_b32 s4, s68, 15
    s_lshl_b32 s4, s4, 1
    s_add_u32 s3, s3, s4
    s_lshl_b32 s4, s28, 5
    s_add_u32 s20, s3, s4
    s_lshl_b32 s3, s20, 11
    s_add_u32 s4, s3, 2048
    v_and_b32 v29, 15, v1
    v_lshrrev_b32 v30, 4, v1
    v_cvt_f32_u32 v31, v29
    v_lshlrev_b32 v32, 2, v30
    v_cvt_f32_u32 v32, v32
    v_lshlrev_b32 v28, 9, v30
    v_lshl_add_u32 v28, v29, 2, v28
    buffer_load_dword v4, v28, s[60:63], s3 offen offset:0
    buffer_load_dword v5, v28, s[60:63], s3 offen offset:128
    buffer_load_dword v6, v28, s[60:63], s3 offen offset:256
    buffer_load_dword v7, v28, s[60:63], s3 offen offset:384
    buffer_load_dword v8, v28, s[60:63], s3 offen offset:64
    buffer_load_dword v9, v28, s[60:63], s3 offen offset:192
    buffer_load_dword v10, v28, s[60:63], s3 offen offset:320
    buffer_load_dword v11, v28, s[60:63], s3 offen offset:448
    buffer_load_dword v12, v28, s[60:63], s4 offen offset:0
    buffer_load_dword v13, v28, s[60:63], s4 offen offset:128
    buffer_load_dword v14, v28, s[60:63], s4 offen offset:256
    buffer_load_dword v15, v28, s[60:63], s4 offen offset:384
    buffer_load_dword v16, v28, s[60:63], s4 offen offset:64
    buffer_load_dword v17, v28, s[60:63], s4 offen offset:192
    buffer_load_dword v18, v28, s[60:63], s4 offen offset:320
    buffer_load_dword v19, v28, s[60:63], s4 offen offset:448
    buffer_load_dword v20, v28, s[64:67], 0 offen offset:0
    buffer_load_dword v21, v28, s[64:67], 0 offen offset:128
    buffer_load_dword v22, v28, s[64:67], 0 offen offset:256
    buffer_load_dword v23, v28, s[64:67], 0 offen offset:384
    buffer_load_dword v24, v28, s[64:67], 0 offen offset:64
    buffer_load_dword v25, v28, s[64:67], 0 offen offset:192
    buffer_load_dword v26, v28, s[64:67], 0 offen offset:320
    buffer_load_dword v27, v28, s[64:67], 0 offen offset:448
    s_mov_b32 s60, s34
    s_mov_b32 s61, s35
    s_mov_b32 s62, 2101248
    s_mov_b32 s63, 0x20000
    s_mov_b32 s64, s36
    s_mov_b32 s65, s37
    s_mov_b32 s66, 2101248
    s_mov_b32 s67, 0x20000
    s_lshl_b32 s26, s28, 7
    v_lshl_add_u32 v236, v1, 1, s26
    v_sub_u32 v237, 1024, v236
    s_mul_i32 s26, s68, 8208
    s_lshl_b32 s27, s68, 3
    s_sub_u32 s27, 2048, s27
    s_and_b32 s27, s27, 2047
    s_mul_i32 s27, s27, 1026
    buffer_load_ushort v196, v236, s[60:63], s26 offen nt
    buffer_load_ushort v212, v236, s[64:67], s26 offen nt
    buffer_load_ushort v197, v237, s[60:63], s27 offen nt
    buffer_load_ushort v213, v237, s[64:67], s27 offen nt
    s_add_u32 s26, s26, 1026
    s_lshl_b32 s27, s68, 3
    s_sub_u32 s27, 2047, s27
    s_and_b32 s27, s27, 2047
    s_mul_i32 s27, s27, 1026
    buffer_load_ushort v198, v236, s[60:63], s26 offen nt
    buffer_load_ushort v214, v236, s[64:67], s26 offen nt
    buffer_load_ushort v199, v237, s[60:63], s27 offen nt
    buffer_load_ushort v215, v237, s[64:67], s27 offen nt
    s_add_u32 s26, s26, 1026
    s_lshl_b32 s27, s68, 3
    s_sub_u32 s27, 2046, s27
    s_and_b32 s27, s27, 2047
    s_mul_i32 s27, s27, 1026
    buffer_load_ushort v200, v236, s[60:63], s26 offen nt
    buffer_load_ushort v216, v236, s[64:67], s26 offen nt
    buffer_load_ushort v201, v237, s[60:63], s27 offen nt
    buffer_load_ushort v217, v237, s[64:67], s27 offen nt
    s_add_u32 s26, s26, 1026
    s_lshl_b32 s27, s68, 3
    s_sub_u32 s27, 2045, s27
    s_and_b32 s27, s27, 2047
    s_mul_i32 s27, s27, 1026
    buffer_load_ushort v202, v236, s[60:63], s26 offen nt
    buffer_load_ushort v218, v236, s[64:67], s26 offen nt
    buffer_load_ushort v203, v237, s[60:63], s27 offen nt
    buffer_load_ushort v219, v237, s[64:67], s27 offen nt
    s_add_u32 s26, s26, 1026
    s_lshl_b32 s27, s68, 3
    s_sub_u32 s27, 2044, s27
    s_and_b32 s27, s27, 2047
    s_mul_i32 s27, s27, 1026
    buffer_load_ushort v204, v236, s[60:63], s26 offen nt
    buffer_load_ushort v220, v236, s[64:67], s26 offen nt
    buffer_load_ushort v205, v237, s[60:63], s27 offen nt
    buffer_load_ushort v221, v237, s[64:67], s27 offen nt
    s_add_u32 s26, s26, 1026
    s_lshl_b32 s27, s68, 3
    s_sub_u32 s27, 2043, s27
    s_and_b32 s27, s27, 2047
    s_mul_i32 s27, s27, 1026
    buffer_load_ushort v206, v236, s[60:63], s26 offen nt
    buffer_load_ushort v222, v236, s[64:67], s26 offen nt
    buffer_load_ushort v207, v237, s[60:63], s27 offen nt
    buffer_load_ushort v223, v237, s[64:67], s27 offen nt
    s_add_u32 s26, s26, 1026
    s_lshl_b32 s27, s68, 3
    s_sub_u32 s27, 2042, s27
    s_and_b32 s27, s27, 2047
    s_mul_i32 s27, s27, 1026
    buffer_load_ushort v208, v236, s[60:63], s26 offen nt
    buffer_load_ushort v224, v236, s[64:67], s26 offen nt
    buffer_load_ushort v209, v237, s[60:63], s27 offen nt
    buffer_load_ushort v225, v237, s[64:67], s27 offen nt
    s_add_u32 s26, s26, 1026
    s_lshl_b32 s27, s68, 3
    s_sub_u32 s27, 2041, s27
    s_and_b32 s27, s27, 2047
    s_mul_i32 s27, s27, 1026
    buffer_load_ushort v210, v236, s[60:63], s26 offen nt
    buffer_load_ushort v226, v236, s[64:67], s26 offen nt
    buffer_load_ushort v211, v237, s[60:63], s27 offen nt
    buffer_load_ushort v227, v237, s[64:67], s27 offen nt
    s_add_u32 s26, s26, 1026
    v_and_b32 v238, 3, v1
    v_lshlrev_b32 v238, 1, v238
    s_lshl_b32 s27, s68, 3
    v_add_u32 v238, s27, v238
    v_bfe_u32 v239, v1, 2, 1
    v_lshlrev_b32 v239, 9, v239
    v_add_u32 v236, 0, v238
    v_sub_u32 v237, 2048, v236
    v_and_b32 v237, 2047, v237
    v_mul_u32_u24 v236, 1026, v236
    v_mul_u32_u24 v237, 1026, v237
    v_add_u32 v236, v236, v239
    v_sub_u32 v237, v237, v239
    v_add_u32 v237, 512, v237
    buffer_load_ushort v228, v236, s[60:63], 0 offen offset:512
    buffer_load_ushort v232, v236, s[64:67], 0 offen offset:512
    buffer_load_ushort v229, v237, s[60:63], 0 offen
    buffer_load_ushort v233, v237, s[64:67], 0 offen
    v_add_u32 v236, 1, v238
    v_sub_u32 v237, 2048, v236
    v_and_b32 v237, 2047, v237
    v_mul_u32_u24 v236, 1026, v236
    v_mul_u32_u24 v237, 1026, v237
    v_add_u32 v236, v236, v239
    v_sub_u32 v237, v237, v239
    v_add_u32 v237, 512, v237
    buffer_load_ushort v230, v236, s[60:63], 0 offen offset:512
    buffer_load_ushort v234, v236, s[64:67], 0 offen offset:512
    buffer_load_ushort v231, v237, s[60:63], 0 offen
    buffer_load_ushort v235, v237, s[64:67], 0 offen
    v_mul_f32 v100, 0x3d800000, v31
    v_mul_f32 v101, v32, v100
    v_mov_b32 v103, v101
    v_fmamk_f32 v105, v100, 0x3f800000, v101
    v_fmamk_f32 v107, v100, 0x40000000, v101
    v_fmamk_f32 v109, v100, 0x40400000, v101
    v_cos_f32 v102, v103
    v_sin_f32 v103, v103
    v_cos_f32 v104, v105
    v_sin_f32 v105, v105
    v_cos_f32 v106, v107
    v_sin_f32 v107, v107
    v_cos_f32 v108, v109
    v_sin_f32 v109, v109
    v_cvt_pk_bf16_f32 v44, v102, v103
    v_cvt_pk_bf16_f32 v48, -v103, v102
    v_cvt_pk_bf16_f32 v45, v104, v105
    v_cvt_pk_bf16_f32 v49, -v105, v104
    v_cvt_pk_bf16_f32 v46, v106, v107
    v_cvt_pk_bf16_f32 v50, -v107, v106
    v_cvt_pk_bf16_f32 v47, v108, v109
    v_cvt_pk_bf16_f32 v51, -v109, v108
    v_mul_f32 v100, 0x3b000000, v31
    v_mul_f32 v101, v32, v100
    v_mov_b32 v53, v101
    v_fmamk_f32 v55, v100, 0x3f800000, v101
    v_fmamk_f32 v57, v100, 0x40000000, v101
    v_fmamk_f32 v59, v100, 0x40400000, v101
    v_fmamk_f32 v61, v100, 0x41800000, v101
    v_fmamk_f32 v63, v100, 0x41880000, v101
    v_fmamk_f32 v65, v100, 0x41900000, v101
    v_fmamk_f32 v67, v100, 0x41980000, v101
    v_cos_f32 v52, v53
    v_sin_f32 v53, v53
    v_cos_f32 v54, v55
    v_sin_f32 v55, v55
    v_cos_f32 v56, v57
    v_sin_f32 v57, v57
    v_cos_f32 v58, v59
    v_sin_f32 v59, v59
    v_cos_f32 v60, v61
    v_sin_f32 v61, v61
    v_cos_f32 v62, v63
    v_sin_f32 v63, v63
    v_cos_f32 v64, v65
    v_sin_f32 v65, v65
    v_cos_f32 v66, v67
    v_sin_f32 v67, v67
    v_mul_f32 v100, 0x3d000000, v31
    v_mul_f32 v101, v32, v100
    v_mov_b32 v103, v101
    v_fmamk_f32 v105, v100, 0x3f800000, v101
    v_fmamk_f32 v107, v100, 0x40000000, v101
    v_fmamk_f32 v109, v100, 0x40400000, v101
    v_cos_f32 v102, v103
    v_sin_f32 v103, v103
    v_cos_f32 v104, v105
    v_sin_f32 v105, v105
    v_cos_f32 v106, v107
    v_sin_f32 v107, v107
    v_cos_f32 v108, v109
    v_sin_f32 v109, v109
    v_and_b32 v110, 1, v1
    v_mul_u32_u24 v110, 0x8000, v110
    v_lshl_or_b32 v110, v110, 16, v110
    v_cvt_pk_bf16_f32 v68, v102, v103
    v_cvt_pk_bf16_f32 v72, -v103, v102
    v_cvt_pk_bf16_f32 v69, v104, v105
    v_cvt_pk_bf16_f32 v73, -v105, v104
    v_cvt_pk_bf16_f32 v70, v106, v107
    v_cvt_pk_bf16_f32 v74, -v107, v106
    v_cvt_pk_bf16_f32 v71, v108, v109
    v_cvt_pk_bf16_f32 v75, -v109, v108
    v_xor_b32 v76, v110, v68
    v_xor_b32 v77, v110, v69
    v_xor_b32 v78, v110, v70
    v_xor_b32 v79, v110, v71
    v_xor_b32 v80, v110, v72
    v_xor_b32 v81, v110, v73
    v_xor_b32 v82, v110, v74
    v_xor_b32 v83, v110, v75
    v_cvt_pk_bf16_f32 v84, v102, v103
    v_cvt_pk_bf16_f32 v88, v103, -v102
    v_cvt_pk_bf16_f32 v85, -v104, -v105
    v_cvt_pk_bf16_f32 v89, -v105, v104
    v_cvt_pk_bf16_f32 v86, v106, v107
    v_cvt_pk_bf16_f32 v90, v107, -v106
    v_cvt_pk_bf16_f32 v87, -v108, -v109
    v_cvt_pk_bf16_f32 v91, -v109, v108
    v_xor_b32 v92, v110, v84
    v_xor_b32 v93, v110, v85
    v_xor_b32 v94, v110, v86
    v_xor_b32 v95, v110, v87
    v_xor_b32 v96, v110, v88
    v_xor_b32 v97, v110, v89
    v_xor_b32 v98, v110, v90
    v_xor_b32 v99, v110, v91
    v_lshlrev_b32 v172, 6, v29
    v_lshl_add_u32 v172, v30, 4, v172
    s_lshl_b32 s6, s28, 11
    s_add_u32 s6, s6, 45056
    v_add_u32 v172, s6, v172
    s_waitcnt vmcnt(48)
    v_mfma_f32_16x16x32_bf16 v[100:103], v[4:7], v[44:47], 0
    v_mfma_f32_16x16x32_bf16 v[104:107], v[4:7], v[48:51], 0
    v_mfma_f32_16x16x32_bf16 v[108:111], v[8:11], v[44:47], 0
    v_mfma_f32_16x16x32_bf16 v[112:115], v[8:11], v[48:51], 0
    s_nop 4
    v_mul_f32 v140, v100, v52
    v_mul_f32 v141, v104, v52
    v_mul_f32 v142, v101, v54
    v_mul_f32 v143, v105, v54
    v_mul_f32 v144, v102, v56
    v_mul_f32 v145, v106, v56
    v_mul_f32 v146, v103, v58
    v_mul_f32 v147, v107, v58
    v_fmac_f32 v140, v104, v53
    v_fma_f32 v141, -v100, v53, v141
    v_fmac_f32 v142, v105, v55
    v_fma_f32 v143, -v101, v55, v143
    v_fmac_f32 v144, v106, v57
    v_fma_f32 v145, -v102, v57, v145
    v_fmac_f32 v146, v107, v59
    v_fma_f32 v147, -v103, v59, v147
    v_cvt_pk_bf16_f32 v116, v140, v141
    v_cvt_pk_bf16_f32 v117, v142, v143
    v_cvt_pk_bf16_f32 v118, v144, v145
    v_cvt_pk_bf16_f32 v119, v146, v147
    v_mul_f32 v140, v108, v60
    v_mul_f32 v141, v112, v60
    v_mul_f32 v142, v109, v62
    v_mul_f32 v143, v113, v62
    v_mul_f32 v144, v110, v64
    v_mul_f32 v145, v114, v64
    v_mul_f32 v146, v111, v66
    v_mul_f32 v147, v115, v66
    v_fmac_f32 v140, v112, v61
    v_fma_f32 v141, -v108, v61, v141
    v_fmac_f32 v142, v113, v63
    v_fma_f32 v143, -v109, v63, v143
    v_fmac_f32 v144, v114, v65
    v_fma_f32 v145, -v110, v65, v145
    v_fmac_f32 v146, v115, v67
    v_fma_f32 v147, -v111, v67, v147
    v_cvt_pk_bf16_f32 v120, v140, v141
    v_cvt_pk_bf16_f32 v121, v142, v143
    v_cvt_pk_bf16_f32 v122, v144, v145
    v_cvt_pk_bf16_f32 v123, v146, v147
    v_mfma_f32_16x16x32_bf16 v[124:127], v[116:119], v[68:71], 0
    v_mfma_f32_16x16x32_bf16 v[128:131], v[116:119], v[72:75], 0
    v_mfma_f32_16x16x32_bf16 v[132:135], v[116:119], v[84:87], 0
    v_mfma_f32_16x16x32_bf16 v[136:139], v[116:119], v[88:91], 0
    v_mfma_f32_16x16x32_bf16 v[124:127], v[120:123], v[76:79], v[124:127]
    v_mfma_f32_16x16x32_bf16 v[128:131], v[120:123], v[80:83], v[128:131]
    v_mfma_f32_16x16x32_bf16 v[132:135], v[120:123], v[92:95], v[132:135]
    v_mfma_f32_16x16x32_bf16 v[136:139], v[120:123], v[96:99], v[136:139]
    s_nop 5
    v_cvt_pk_bf16_f32 v156, v124, v128
    v_cvt_pk_bf16_f32 v157, v125, v129
    v_cvt_pk_bf16_f32 v158, v126, v130
    v_cvt_pk_bf16_f32 v159, v127, v131
    ds_write_b128 v172, v[156:159] offset:0
    v_cvt_pk_bf16_f32 v160, v132, v136
    v_cvt_pk_bf16_f32 v161, v133, v137
    v_cvt_pk_bf16_f32 v162, v134, v138
    v_cvt_pk_bf16_f32 v163, v135, v139
    ds_write_b128 v172, v[160:163] offset:1024
    v_mfma_f32_16x16x32_bf16 v[100:103], v[12:15], v[44:47], 0
    v_mfma_f32_16x16x32_bf16 v[104:107], v[12:15], v[48:51], 0
    v_mfma_f32_16x16x32_bf16 v[108:111], v[16:19], v[44:47], 0
    v_mfma_f32_16x16x32_bf16 v[112:115], v[16:19], v[48:51], 0
    s_nop 4
    v_mul_f32 v140, v100, v52
    v_mul_f32 v141, v104, v52
    v_mul_f32 v142, v101, v54
    v_mul_f32 v143, v105, v54
    v_mul_f32 v144, v102, v56
    v_mul_f32 v145, v106, v56
    v_mul_f32 v146, v103, v58
    v_mul_f32 v147, v107, v58
    v_fmac_f32 v140, v104, v53
    v_fma_f32 v141, -v100, v53, v141
    v_fmac_f32 v142, v105, v55
    v_fma_f32 v143, -v101, v55, v143
    v_fmac_f32 v144, v106, v57
    v_fma_f32 v145, -v102, v57, v145
    v_fmac_f32 v146, v107, v59
    v_fma_f32 v147, -v103, v59, v147
    v_cvt_pk_bf16_f32 v116, v140, v141
    v_cvt_pk_bf16_f32 v117, v142, v143
    v_cvt_pk_bf16_f32 v118, v144, v145
    v_cvt_pk_bf16_f32 v119, v146, v147
    v_mul_f32 v140, v108, v60
    v_mul_f32 v141, v112, v60
    v_mul_f32 v142, v109, v62
    v_mul_f32 v143, v113, v62
    v_mul_f32 v144, v110, v64
    v_mul_f32 v145, v114, v64
    v_mul_f32 v146, v111, v66
    v_mul_f32 v147, v115, v66
    v_fmac_f32 v140, v112, v61
    v_fma_f32 v141, -v108, v61, v141
    v_fmac_f32 v142, v113, v63
    v_fma_f32 v143, -v109, v63, v143
    v_fmac_f32 v144, v114, v65
    v_fma_f32 v145, -v110, v65, v145
    v_fmac_f32 v146, v115, v67
    v_fma_f32 v147, -v111, v67, v147
    v_cvt_pk_bf16_f32 v120, v140, v141
    v_cvt_pk_bf16_f32 v121, v142, v143
    v_cvt_pk_bf16_f32 v122, v144, v145
    v_cvt_pk_bf16_f32 v123, v146, v147
    v_mfma_f32_16x16x32_bf16 v[124:127], v[116:119], v[68:71], 0
    v_mfma_f32_16x16x32_bf16 v[128:131], v[116:119], v[72:75], 0
    v_mfma_f32_16x16x32_bf16 v[132:135], v[116:119], v[84:87], 0
    v_mfma_f32_16x16x32_bf16 v[136:139], v[116:119], v[88:91], 0
    v_mfma_f32_16x16x32_bf16 v[124:127], v[120:123], v[76:79], v[124:127]
    v_mfma_f32_16x16x32_bf16 v[128:131], v[120:123], v[80:83], v[128:131]
    v_mfma_f32_16x16x32_bf16 v[132:135], v[120:123], v[92:95], v[132:135]
    v_mfma_f32_16x16x32_bf16 v[136:139], v[120:123], v[96:99], v[136:139]
    s_nop 5
    v_cvt_pk_bf16_f32 v164, v124, v128
    v_cvt_pk_bf16_f32 v165, v125, v129
    v_cvt_pk_bf16_f32 v166, v126, v130
    v_cvt_pk_bf16_f32 v167, v127, v131
    ds_write_b128 v172, v[164:167] offset:8192
    v_cvt_pk_bf16_f32 v168, v132, v136
    v_cvt_pk_bf16_f32 v169, v133, v137
    v_cvt_pk_bf16_f32 v170, v134, v138
    v_cvt_pk_bf16_f32 v171, v135, v139
    ds_write_b128 v172, v[168:171] offset:9216
    s_waitcnt vmcnt(40)
    s_lshl_b32 s26, s28, 12
    s_add_u32 s26, s26, 61440
    v_lshl_add_u32 v238, v1, 6, s26
    v_lshl_add_u32 v239, v1, 4, s26
    v_lshrrev_b32 v240, 3, v1
    v_lshlrev_b32 v240, 15, v240
    v_and_b32 v236, 7, v1
    v_lshl_add_u32 v240, v236, 4, v240
    s_lshl_b32 s26, s68, 7
    s_add_u32 s26, s26, 20971520
    s_lshl_b32 s27, s28, 20
    s_add_u32 s27, s27, s26
    s_waitcnt vmcnt(8)
    v_lshl_or_b32 v196, v212, 16, v196
    v_lshl_or_b32 v197, v213, 16, v197
    v_lshl_or_b32 v198, v214, 16, v198
    v_lshl_or_b32 v199, v215, 16, v199
    v_lshl_or_b32 v200, v216, 16, v200
    v_lshl_or_b32 v201, v217, 16, v201
    v_lshl_or_b32 v202, v218, 16, v202
    v_lshl_or_b32 v203, v219, 16, v203
    v_lshl_or_b32 v204, v220, 16, v204
    v_lshl_or_b32 v205, v221, 16, v205
    v_lshl_or_b32 v206, v222, 16, v206
    v_lshl_or_b32 v207, v223, 16, v207
    v_lshl_or_b32 v208, v224, 16, v208
    v_lshl_or_b32 v209, v225, 16, v209
    v_lshl_or_b32 v210, v226, 16, v210
    v_lshl_or_b32 v211, v227, 16, v211
    ds_write_b128 v238, v[196:199] offset:0
    ds_write_b128 v238, v[200:203] offset:16
    ds_write_b128 v238, v[204:207] offset:32
    ds_write_b128 v238, v[208:211] offset:48
    s_waitcnt lgkmcnt(0)
    ds_read_b128 v[212:215], v239 offset:0
    ds_read_b128 v[216:219], v239 offset:1024
    ds_read_b128 v[220:223], v239 offset:2048
    ds_read_b128 v[224:227], v239 offset:3072
    s_waitcnt vmcnt(0)
    v_lshl_or_b32 v228, v232, 16, v228
    v_lshl_or_b32 v229, v233, 16, v229
    v_lshl_or_b32 v230, v234, 16, v230
    v_lshl_or_b32 v231, v235, 16, v231
    s_waitcnt lgkmcnt(3)
    buffer_store_dwordx4 v[212:215], v240, s[56:59], s27 offen sc1
    s_add_u32 s27, s27, 262144
    s_waitcnt lgkmcnt(2)
    buffer_store_dwordx4 v[216:219], v240, s[56:59], s27 offen sc1
    s_add_u32 s27, s27, 262144
    s_waitcnt lgkmcnt(1)
    buffer_store_dwordx4 v[220:223], v240, s[56:59], s27 offen sc1
    s_add_u32 s27, s27, 262144
    s_waitcnt lgkmcnt(0)
    buffer_store_dwordx4 v[224:227], v240, s[56:59], s27 offen sc1
    s_add_u32 s27, s27, 262144
    s_add_u32 s26, s26, 4194304
    s_cmp_eq_u32 s28, 0
    s_cselect_b64 exec, 0xff, 0
    s_cbranch_execz Lskip_1501
    buffer_store_dwordx4 v[228:231], v240, s[56:59], s26 offen sc1
Lskip_1501:
    s_mov_b64 exec, -1
    v_lshlrev_b32 v100, 16, v20
    v_and_b32 v101, 0xffff0000, v20
    v_lshlrev_b32 v102, 16, v21
    v_and_b32 v103, 0xffff0000, v21
    v_lshlrev_b32 v104, 16, v22
    v_and_b32 v105, 0xffff0000, v22
    v_lshlrev_b32 v106, 16, v23
    v_and_b32 v107, 0xffff0000, v23
    v_lshlrev_b32 v108, 16, v24
    v_and_b32 v109, 0xffff0000, v24
    v_lshlrev_b32 v110, 16, v25
    v_and_b32 v111, 0xffff0000, v25
    v_lshlrev_b32 v112, 16, v26
    v_and_b32 v113, 0xffff0000, v26
    v_lshlrev_b32 v114, 16, v27
    v_and_b32 v115, 0xffff0000, v27
    v_mov_b32 v41, 0x3f803f80
    v_lshlrev_b32 v140, 16, v4
    v_and_b32 v141, 0xffff0000, v4
    v_lshlrev_b32 v142, 16, v5
    v_and_b32 v143, 0xffff0000, v5
    v_lshlrev_b32 v144, 16, v6
    v_and_b32 v145, 0xffff0000, v6
    v_lshlrev_b32 v146, 16, v7
    v_and_b32 v147, 0xffff0000, v7
    v_lshlrev_b32 v148, 16, v8
    v_and_b32 v149, 0xffff0000, v8
    v_lshlrev_b32 v150, 16, v9
    v_and_b32 v151, 0xffff0000, v9
    v_lshlrev_b32 v152, 16, v10
    v_and_b32 v153, 0xffff0000, v10
    v_lshlrev_b32 v154, 16, v11
    v_and_b32 v155, 0xffff0000, v11
    v_pk_mul_f32 v[140:141], v[140:141], v[100:101]
    v_pk_mul_f32 v[142:143], v[142:143], v[102:103]
    v_pk_mul_f32 v[144:145], v[144:145], v[104:105]
    v_pk_mul_f32 v[146:147], v[146:147], v[106:107]
    v_pk_mul_f32 v[148:149], v[148:149], v[108:109]
    v_pk_mul_f32 v[150:151], v[150:151], v[110:111]
    v_pk_mul_f32 v[152:153], v[152:153], v[112:113]
    v_pk_mul_f32 v[154:155], v[154:155], v[114:115]
    v_cvt_pk_bf16_f32 v140, v140, v141
    v_cvt_pk_bf16_f32 v142, v142, v143
    v_cvt_pk_bf16_f32 v144, v144, v145
    v_cvt_pk_bf16_f32 v146, v146, v147
    v_cvt_pk_bf16_f32 v148, v148, v149
    v_cvt_pk_bf16_f32 v150, v150, v151
    v_cvt_pk_bf16_f32 v152, v152, v153
    v_cvt_pk_bf16_f32 v154, v154, v155
    v_mov_b32 v174, 0
    v_dot2_f32_bf16 v174, v140, v41, v174
    v_dot2_f32_bf16 v174, v142, v41, v174
    v_dot2_f32_bf16 v174, v144, v41, v174
    v_dot2_f32_bf16 v174, v146, v41, v174
    v_dot2_f32_bf16 v174, v148, v41, v174
    v_dot2_f32_bf16 v174, v150, v41, v174
    v_dot2_f32_bf16 v174, v152, v41, v174
    v_dot2_f32_bf16 v174, v154, v41, v174
    s_nop 2
    v_lshlrev_b32 v140, 16, v12
    v_and_b32 v141, 0xffff0000, v12
    v_lshlrev_b32 v142, 16, v13
    v_and_b32 v143, 0xffff0000, v13
    v_lshlrev_b32 v144, 16, v14
    v_and_b32 v145, 0xffff0000, v14
    v_lshlrev_b32 v146, 16, v15
    v_and_b32 v147, 0xffff0000, v15
    v_lshlrev_b32 v148, 16, v16
    v_and_b32 v149, 0xffff0000, v16
    v_lshlrev_b32 v150, 16, v17
    v_and_b32 v151, 0xffff0000, v17
    v_lshlrev_b32 v152, 16, v18
    v_and_b32 v153, 0xffff0000, v18
    v_lshlrev_b32 v154, 16, v19
    v_and_b32 v155, 0xffff0000, v19
    v_pk_mul_f32 v[140:141], v[140:141], v[100:101]
    v_pk_mul_f32 v[142:143], v[142:143], v[102:103]
    v_pk_mul_f32 v[144:145], v[144:145], v[104:105]
    v_pk_mul_f32 v[146:147], v[146:147], v[106:107]
    v_pk_mul_f32 v[148:149], v[148:149], v[108:109]
    v_pk_mul_f32 v[150:151], v[150:151], v[110:111]
    v_pk_mul_f32 v[152:153], v[152:153], v[112:113]
    v_pk_mul_f32 v[154:155], v[154:155], v[114:115]
    v_cvt_pk_bf16_f32 v140, v140, v141
    v_cvt_pk_bf16_f32 v142, v142, v143
    v_cvt_pk_bf16_f32 v144, v144, v145
    v_cvt_pk_bf16_f32 v146, v146, v147
    v_cvt_pk_bf16_f32 v148, v148, v149
    v_cvt_pk_bf16_f32 v150, v150, v151
    v_cvt_pk_bf16_f32 v152, v152, v153
    v_cvt_pk_bf16_f32 v154, v154, v155
    v_mov_b32 v175, 0
    v_dot2_f32_bf16 v175, v140, v41, v175
    v_dot2_f32_bf16 v175, v142, v41, v175
    v_dot2_f32_bf16 v175, v144, v41, v175
    v_dot2_f32_bf16 v175, v146, v41, v175
    v_dot2_f32_bf16 v175, v148, v41, v175
    v_dot2_f32_bf16 v175, v150, v41, v175
    v_dot2_f32_bf16 v175, v152, v41, v175
    v_dot2_f32_bf16 v175, v154, v41, v175
    s_nop 2
    v_add_f32_dpp v174, v174, v174 row_shr:1 bound_ctrl:0
    v_add_f32_dpp v175, v175, v175 row_shr:1 bound_ctrl:0
    s_nop 0
    v_add_f32_dpp v174, v174, v174 row_shr:2 bound_ctrl:0
    v_add_f32_dpp v175, v175, v175 row_shr:2 bound_ctrl:0
    s_nop 0
    v_add_f32_dpp v174, v174, v174 row_shr:4 bound_ctrl:0
    v_add_f32_dpp v175, v175, v175 row_shr:4 bound_ctrl:0
    s_nop 0
    v_add_f32_dpp v174, v174, v174 row_shr:8 bound_ctrl:0
    v_add_f32_dpp v175, v175, v175 row_shr:8 bound_ctrl:0
    s_nop 0
    v_add_f32_dpp v174, v174, v174 row_bcast:15 row_mask:0xa
    v_add_f32_dpp v175, v175, v175 row_bcast:15 row_mask:0xa
    s_nop 0
    v_add_f32_dpp v174, v174, v174 row_bcast:31 row_mask:0xc
    v_add_f32_dpp v175, v175, v175 row_bcast:31 row_mask:0xc
    v_cvt_pk_bf16_f32 v42, v174, v175
    v_lshlrev_b32 v174, 16, v42
    v_and_b32 v175, 0xffff0000, v42
    v_mul_f32 v174, 0xbfb8aa3b, v174
    v_mul_f32 v175, 0xbfb8aa3b, v175
    v_exp_f32 v174, v174
    v_exp_f32 v175, v175
    v_add_f32 v174, 1.0, v174
    v_add_f32 v175, 1.0, v175
    v_rcp_f32 v174, v174
    v_rcp_f32 v175, v175
    s_nop 0
    v_cvt_pk_bf16_f32 v42, v174, v175
    v_lshlrev_b32 v174, 16, v42
    v_and_b32 v175, 0xffff0000, v42
    s_lshl_b32 s6, s68, 2
    s_add_u32 s6, s6, s28
    s_lshl_b32 s6, s6, 7
    s_add_u32 s6, s6, 26214400
    v_mov_b32 v42, 0
    s_mov_b64 s[22:23], exec
    s_lshl_b64 exec, 1, 63
    buffer_store_dwordx2 v[174:175], v42, s[56:59], s6 offen sc1
    s_mov_b64 exec, s[22:23]
    v_lshrrev_b32 v176, 3, v1
    v_lshlrev_b32 v176, 15, v176
    v_and_b32 v42, 7, v1
    v_lshl_add_u32 v176, v42, 4, v176
    s_waitcnt lgkmcnt(0)
    v_mov_b32 v140, 151584
    v_mov_b32 v141, 1
    s_mov_b64 exec, 1
    ds_add_u32 v140, v141
Lcb_8:
    ds_read_b32 v141, v140
    s_waitcnt lgkmcnt(0)
    v_readfirstlane_b32 s7, v141
    s_nop 0
    s_cmp_ge_u32 s7, 4
    s_cbranch_scc0 Lcb_8
    s_mov_b64 exec, -1
    v_lshrrev_b32 v41, 2, v1
    s_lshl_b32 s6, s28, 6
    v_add_u32 v41, s6, v41
    v_sub_u32 v42, 512, v41
    v_and_b32 v43, 1, v1
    v_cmp_ne_u32 vcc, 0, v43
    s_nop 1
    v_cndmask_b32 v41, v41, v42, vcc
    v_mov_b32 v40, 64
    v_mov_b32 v42, -64
    v_cndmask_b32 v40, v40, v42, vcc
    v_lshlrev_b32 v41, 2, v41
    v_and_b32 v43, 2, v1
    v_lshlrev_b32 v43, 12, v43
    v_add_u32 v43, 45056, v43
    v_add_u32 v37, v41, v43
    v_mov_b32 v42, 1024
    v_cmp_eq_u32 vcc, 2048, v41
    s_nop 1
    v_cndmask_b32 v42, v41, v42, vcc
    v_add_u32 v36, v42, v43
    v_add_u32 v37, v40, v37
    v_add_u32 v38, v40, v37
    v_add_u32 v39, v40, v38
    ds_read2st64_b32 v[156:157], v36 offset0:0 offset1:8
    ds_read2st64_b32 v[158:159], v36 offset0:16 offset1:24
    ds_read2st64_b32 v[160:161], v37 offset0:0 offset1:8
    ds_read2st64_b32 v[162:163], v37 offset0:16 offset1:24
    ds_read2st64_b32 v[164:165], v38 offset0:0 offset1:8
    ds_read2st64_b32 v[166:167], v38 offset0:16 offset1:24
    ds_read2st64_b32 v[168:169], v39 offset0:0 offset1:8
    ds_read2st64_b32 v[170:171], v39 offset0:16 offset1:24
    s_lshl_b32 s5, s68, 7
    s_add_u32 s5, s5, 16777216
    s_lshl_b32 s6, s28, 20
    s_add_u32 s6, s6, s5
    s_waitcnt lgkmcnt(6)
    buffer_store_dwordx4 v[156:159], v176, s[56:59], s6 offen sc1
    s_add_u32 s6, s6, 262144
    s_waitcnt lgkmcnt(4)
    buffer_store_dwordx4 v[160:163], v176, s[56:59], s6 offen sc1
    s_add_u32 s6, s6, 262144
    s_waitcnt lgkmcnt(2)
    buffer_store_dwordx4 v[164:167], v176, s[56:59], s6 offen sc1
    s_add_u32 s6, s6, 262144
    s_waitcnt lgkmcnt(0)
    buffer_store_dwordx4 v[168:171], v176, s[56:59], s6 offen sc1
    s_add_u32 s6, s6, 262144
    s_branch Lgrpd_7
Lgrp1_6:
    s_mov_b32 s60, s32
    s_mov_b32 s61, s33
    s_mov_b32 s62, 4194304
    s_mov_b32 s63, 0x20000
    s_mov_b32 s64, s48
    s_mov_b32 s65, s49
    s_mov_b32 s66, 2048
    s_mov_b32 s67, 0x20000
    s_lshr_b32 s3, s68, 4
    s_lshl_b32 s3, s3, 7
    s_and_b32 s4, s68, 15
    s_lshl_b32 s4, s4, 1
    s_add_u32 s3, s3, s4
    s_lshl_b32 s4, s28, 5
    s_add_u32 s20, s3, s4
    s_lshl_b32 s3, s20, 11
    s_add_u32 s4, s3, 2048
    v_and_b32 v29, 15, v1
    v_lshrrev_b32 v30, 4, v1
    v_cvt_f32_u32 v31, v29
    v_lshlrev_b32 v32, 2, v30
    v_cvt_f32_u32 v32, v32
    v_lshlrev_b32 v28, 9, v30
    v_lshl_add_u32 v28, v29, 2, v28
    buffer_load_dword v4, v28, s[60:63], s3 offen offset:0
    buffer_load_dword v5, v28, s[60:63], s3 offen offset:128
    buffer_load_dword v6, v28, s[60:63], s3 offen offset:256
    buffer_load_dword v7, v28, s[60:63], s3 offen offset:384
    buffer_load_dword v8, v28, s[60:63], s3 offen offset:64
    buffer_load_dword v9, v28, s[60:63], s3 offen offset:192
    buffer_load_dword v10, v28, s[60:63], s3 offen offset:320
    buffer_load_dword v11, v28, s[60:63], s3 offen offset:448
    buffer_load_dword v12, v28, s[60:63], s4 offen offset:0
    buffer_load_dword v13, v28, s[60:63], s4 offen offset:128
    buffer_load_dword v14, v28, s[60:63], s4 offen offset:256
    buffer_load_dword v15, v28, s[60:63], s4 offen offset:384
    buffer_load_dword v16, v28, s[60:63], s4 offen offset:64
    buffer_load_dword v17, v28, s[60:63], s4 offen offset:192
    buffer_load_dword v18, v28, s[60:63], s4 offen offset:320
    buffer_load_dword v19, v28, s[60:63], s4 offen offset:448
    buffer_load_dword v20, v28, s[64:67], 0 offen offset:0
    buffer_load_dword v21, v28, s[64:67], 0 offen offset:128
    buffer_load_dword v22, v28, s[64:67], 0 offen offset:256
    buffer_load_dword v23, v28, s[64:67], 0 offen offset:384
    buffer_load_dword v24, v28, s[64:67], 0 offen offset:64
    buffer_load_dword v25, v28, s[64:67], 0 offen offset:192
    buffer_load_dword v26, v28, s[64:67], 0 offen offset:320
    buffer_load_dword v27, v28, s[64:67], 0 offen offset:448
    s_mov_b32 s60, s34
    s_mov_b32 s61, s35
    s_mov_b32 s62, 2101248
    s_mov_b32 s63, 0x20000
    s_mov_b32 s64, s36
    s_mov_b32 s65, s37
    s_mov_b32 s66, 2101248
    s_mov_b32 s67, 0x20000
    s_lshl_b32 s26, s28, 7
    v_lshl_add_u32 v236, v1, 1, s26
    v_sub_u32 v237, 1024, v236
    s_mul_i32 s26, s68, 8208
    s_lshl_b32 s27, s68, 3
    s_sub_u32 s27, 2048, s27
    s_and_b32 s27, s27, 2047
    s_mul_i32 s27, s27, 1026
    buffer_load_ushort v196, v236, s[60:63], s26 offen nt
    buffer_load_ushort v212, v236, s[64:67], s26 offen nt
    buffer_load_ushort v197, v237, s[60:63], s27 offen nt
    buffer_load_ushort v213, v237, s[64:67], s27 offen nt
    s_add_u32 s26, s26, 1026
    s_lshl_b32 s27, s68, 3
    s_sub_u32 s27, 2047, s27
    s_and_b32 s27, s27, 2047
    s_mul_i32 s27, s27, 1026
    buffer_load_ushort v198, v236, s[60:63], s26 offen nt
    buffer_load_ushort v214, v236, s[64:67], s26 offen nt
    buffer_load_ushort v199, v237, s[60:63], s27 offen nt
    buffer_load_ushort v215, v237, s[64:67], s27 offen nt
    s_add_u32 s26, s26, 1026
    s_lshl_b32 s27, s68, 3
    s_sub_u32 s27, 2046, s27
    s_and_b32 s27, s27, 2047
    s_mul_i32 s27, s27, 1026
    buffer_load_ushort v200, v236, s[60:63], s26 offen nt
    buffer_load_ushort v216, v236, s[64:67], s26 offen nt
    buffer_load_ushort v201, v237, s[60:63], s27 offen nt
    buffer_load_ushort v217, v237, s[64:67], s27 offen nt
    s_add_u32 s26, s26, 1026
    s_lshl_b32 s27, s68, 3
    s_sub_u32 s27, 2045, s27
    s_and_b32 s27, s27, 2047
    s_mul_i32 s27, s27, 1026
    buffer_load_ushort v202, v236, s[60:63], s26 offen nt
    buffer_load_ushort v218, v236, s[64:67], s26 offen nt
    buffer_load_ushort v203, v237, s[60:63], s27 offen nt
    buffer_load_ushort v219, v237, s[64:67], s27 offen nt
    s_add_u32 s26, s26, 1026
    s_lshl_b32 s27, s68, 3
    s_sub_u32 s27, 2044, s27
    s_and_b32 s27, s27, 2047
    s_mul_i32 s27, s27, 1026
    buffer_load_ushort v204, v236, s[60:63], s26 offen nt
    buffer_load_ushort v220, v236, s[64:67], s26 offen nt
    buffer_load_ushort v205, v237, s[60:63], s27 offen nt
    buffer_load_ushort v221, v237, s[64:67], s27 offen nt
    s_add_u32 s26, s26, 1026
    s_lshl_b32 s27, s68, 3
    s_sub_u32 s27, 2043, s27
    s_and_b32 s27, s27, 2047
    s_mul_i32 s27, s27, 1026
    buffer_load_ushort v206, v236, s[60:63], s26 offen nt
    buffer_load_ushort v222, v236, s[64:67], s26 offen nt
    buffer_load_ushort v207, v237, s[60:63], s27 offen nt
    buffer_load_ushort v223, v237, s[64:67], s27 offen nt
    s_add_u32 s26, s26, 1026
    s_lshl_b32 s27, s68, 3
    s_sub_u32 s27, 2042, s27
    s_and_b32 s27, s27, 2047
    s_mul_i32 s27, s27, 1026
    buffer_load_ushort v208, v236, s[60:63], s26 offen nt
    buffer_load_ushort v224, v236, s[64:67], s26 offen nt
    buffer_load_ushort v209, v237, s[60:63], s27 offen nt
    buffer_load_ushort v225, v237, s[64:67], s27 offen nt
    s_add_u32 s26, s26, 1026
    s_lshl_b32 s27, s68, 3
    s_sub_u32 s27, 2041, s27
    s_and_b32 s27, s27, 2047
    s_mul_i32 s27, s27, 1026
    buffer_load_ushort v210, v236, s[60:63], s26 offen nt
    buffer_load_ushort v226, v236, s[64:67], s26 offen nt
    buffer_load_ushort v211, v237, s[60:63], s27 offen nt
    buffer_load_ushort v227, v237, s[64:67], s27 offen nt
    s_add_u32 s26, s26, 1026
    v_and_b32 v238, 3, v1
    v_lshlrev_b32 v238, 1, v238
    s_lshl_b32 s27, s68, 3
    v_add_u32 v238, s27, v238
    v_bfe_u32 v239, v1, 2, 1
    v_lshlrev_b32 v239, 9, v239
    v_add_u32 v236, 0, v238
    v_sub_u32 v237, 2048, v236
    v_and_b32 v237, 2047, v237
    v_mul_u32_u24 v236, 1026, v236
    v_mul_u32_u24 v237, 1026, v237
    v_add_u32 v236, v236, v239
    v_sub_u32 v237, v237, v239
    v_add_u32 v237, 512, v237
    buffer_load_ushort v228, v236, s[60:63], 0 offen offset:512
    buffer_load_ushort v232, v236, s[64:67], 0 offen offset:512
    buffer_load_ushort v229, v237, s[60:63], 0 offen
    buffer_load_ushort v233, v237, s[64:67], 0 offen
    v_add_u32 v236, 1, v238
    v_sub_u32 v237, 2048, v236
    v_and_b32 v237, 2047, v237
    v_mul_u32_u24 v236, 1026, v236
    v_mul_u32_u24 v237, 1026, v237
    v_add_u32 v236, v236, v239
    v_sub_u32 v237, v237, v239
    v_add_u32 v237, 512, v237
    buffer_load_ushort v230, v236, s[60:63], 0 offen offset:512
    buffer_load_ushort v234, v236, s[64:67], 0 offen offset:512
    buffer_load_ushort v231, v237, s[60:63], 0 offen
    buffer_load_ushort v235, v237, s[64:67], 0 offen
    v_mul_f32 v100, 0x3d800000, v31
    v_mul_f32 v101, v32, v100
    v_mov_b32 v103, v101
    v_fmamk_f32 v105, v100, 0x3f800000, v101
    v_fmamk_f32 v107, v100, 0x40000000, v101
    v_fmamk_f32 v109, v100, 0x40400000, v101
    v_cos_f32 v102, v103
    v_sin_f32 v103, v103
    v_cos_f32 v104, v105
    v_sin_f32 v105, v105
    v_cos_f32 v106, v107
    v_sin_f32 v107, v107
    v_cos_f32 v108, v109
    v_sin_f32 v109, v109
    v_cvt_pk_bf16_f32 v44, v102, v103
    v_cvt_pk_bf16_f32 v48, -v103, v102
    v_cvt_pk_bf16_f32 v45, v104, v105
    v_cvt_pk_bf16_f32 v49, -v105, v104
    v_cvt_pk_bf16_f32 v46, v106, v107
    v_cvt_pk_bf16_f32 v50, -v107, v106
    v_cvt_pk_bf16_f32 v47, v108, v109
    v_cvt_pk_bf16_f32 v51, -v109, v108
    v_mul_f32 v100, 0x3b000000, v31
    v_mul_f32 v101, v32, v100
    v_mov_b32 v53, v101
    v_fmamk_f32 v55, v100, 0x3f800000, v101
    v_fmamk_f32 v57, v100, 0x40000000, v101
    v_fmamk_f32 v59, v100, 0x40400000, v101
    v_fmamk_f32 v61, v100, 0x41800000, v101
    v_fmamk_f32 v63, v100, 0x41880000, v101
    v_fmamk_f32 v65, v100, 0x41900000, v101
    v_fmamk_f32 v67, v100, 0x41980000, v101
    v_cos_f32 v52, v53
    v_sin_f32 v53, v53
    v_cos_f32 v54, v55
    v_sin_f32 v55, v55
    v_cos_f32 v56, v57
    v_sin_f32 v57, v57
    v_cos_f32 v58, v59
    v_sin_f32 v59, v59
    v_cos_f32 v60, v61
    v_sin_f32 v61, v61
    v_cos_f32 v62, v63
    v_sin_f32 v63, v63
    v_cos_f32 v64, v65
    v_sin_f32 v65, v65
    v_cos_f32 v66, v67
    v_sin_f32 v67, v67
    v_mul_f32 v100, 0x3d000000, v31
    v_mul_f32 v101, v32, v100
    v_mov_b32 v103, v101
    v_fmamk_f32 v105, v100, 0x3f800000, v101
    v_fmamk_f32 v107, v100, 0x40000000, v101
    v_fmamk_f32 v109, v100, 0x40400000, v101
    v_cos_f32 v102, v103
    v_sin_f32 v103, v103
    v_cos_f32 v104, v105
    v_sin_f32 v105, v105
    v_cos_f32 v106, v107
    v_sin_f32 v107, v107
    v_cos_f32 v108, v109
    v_sin_f32 v109, v109
    v_and_b32 v110, 1, v1
    v_mul_u32_u24 v110, 0x8000, v110
    v_lshl_or_b32 v110, v110, 16, v110
    v_cvt_pk_bf16_f32 v68, v102, v103
    v_cvt_pk_bf16_f32 v72, -v103, v102
    v_cvt_pk_bf16_f32 v69, v104, v105
    v_cvt_pk_bf16_f32 v73, -v105, v104
    v_cvt_pk_bf16_f32 v70, v106, v107
    v_cvt_pk_bf16_f32 v74, -v107, v106
    v_cvt_pk_bf16_f32 v71, v108, v109
    v_cvt_pk_bf16_f32 v75, -v109, v108
    v_xor_b32 v76, v110, v68
    v_xor_b32 v77, v110, v69
    v_xor_b32 v78, v110, v70
    v_xor_b32 v79, v110, v71
    v_xor_b32 v80, v110, v72
    v_xor_b32 v81, v110, v73
    v_xor_b32 v82, v110, v74
    v_xor_b32 v83, v110, v75
    v_cvt_pk_bf16_f32 v84, v102, v103
    v_cvt_pk_bf16_f32 v88, v103, -v102
    v_cvt_pk_bf16_f32 v85, -v104, -v105
    v_cvt_pk_bf16_f32 v89, -v105, v104
    v_cvt_pk_bf16_f32 v86, v106, v107
    v_cvt_pk_bf16_f32 v90, v107, -v106
    v_cvt_pk_bf16_f32 v87, -v108, -v109
    v_cvt_pk_bf16_f32 v91, -v109, v108
    v_xor_b32 v92, v110, v84
    v_xor_b32 v93, v110, v85
    v_xor_b32 v94, v110, v86
    v_xor_b32 v95, v110, v87
    v_xor_b32 v96, v110, v88
    v_xor_b32 v97, v110, v89
    v_xor_b32 v98, v110, v90
    v_xor_b32 v99, v110, v91
    v_lshlrev_b32 v172, 6, v29
    v_lshl_add_u32 v172, v30, 4, v172
    s_lshl_b32 s6, s28, 11
    s_add_u32 s6, s6, 77824
    v_add_u32 v172, s6, v172
    s_waitcnt vmcnt(48)
    v_mfma_f32_16x16x32_bf16 v[100:103], v[4:7], v[44:47], 0
    v_mfma_f32_16x16x32_bf16 v[104:107], v[4:7], v[48:51], 0
    v_mfma_f32_16x16x32_bf16 v[108:111], v[8:11], v[44:47], 0
    v_mfma_f32_16x16x32_bf16 v[112:115], v[8:11], v[48:51], 0
    s_nop 4
    v_mul_f32 v140, v100, v52
    v_mul_f32 v141, v104, v52
    v_mul_f32 v142, v101, v54
    v_mul_f32 v143, v105, v54
    v_mul_f32 v144, v102, v56
    v_mul_f32 v145, v106, v56
    v_mul_f32 v146, v103, v58
    v_mul_f32 v147, v107, v58
    v_fmac_f32 v140, v104, v53
    v_fma_f32 v141, -v100, v53, v141
    v_fmac_f32 v142, v105, v55
    v_fma_f32 v143, -v101, v55, v143
    v_fmac_f32 v144, v106, v57
    v_fma_f32 v145, -v102, v57, v145
    v_fmac_f32 v146, v107, v59
    v_fma_f32 v147, -v103, v59, v147
    v_cvt_pk_bf16_f32 v116, v140, v141
    v_cvt_pk_bf16_f32 v117, v142, v143
    v_cvt_pk_bf16_f32 v118, v144, v145
    v_cvt_pk_bf16_f32 v119, v146, v147
    v_mul_f32 v140, v108, v60
    v_mul_f32 v141, v112, v60
    v_mul_f32 v142, v109, v62
    v_mul_f32 v143, v113, v62
    v_mul_f32 v144, v110, v64
    v_mul_f32 v145, v114, v64
    v_mul_f32 v146, v111, v66
    v_mul_f32 v147, v115, v66
    v_fmac_f32 v140, v112, v61
    v_fma_f32 v141, -v108, v61, v141
    v_fmac_f32 v142, v113, v63
    v_fma_f32 v143, -v109, v63, v143
    v_fmac_f32 v144, v114, v65
    v_fma_f32 v145, -v110, v65, v145
    v_fmac_f32 v146, v115, v67
    v_fma_f32 v147, -v111, v67, v147
    v_cvt_pk_bf16_f32 v120, v140, v141
    v_cvt_pk_bf16_f32 v121, v142, v143
    v_cvt_pk_bf16_f32 v122, v144, v145
    v_cvt_pk_bf16_f32 v123, v146, v147
    v_mfma_f32_16x16x32_bf16 v[124:127], v[116:119], v[68:71], 0
    v_mfma_f32_16x16x32_bf16 v[128:131], v[116:119], v[72:75], 0
    v_mfma_f32_16x16x32_bf16 v[132:135], v[116:119], v[84:87], 0
    v_mfma_f32_16x16x32_bf16 v[136:139], v[116:119], v[88:91], 0
    v_mfma_f32_16x16x32_bf16 v[124:127], v[120:123], v[76:79], v[124:127]
    v_mfma_f32_16x16x32_bf16 v[128:131], v[120:123], v[80:83], v[128:131]
    v_mfma_f32_16x16x32_bf16 v[132:135], v[120:123], v[92:95], v[132:135]
    v_mfma_f32_16x16x32_bf16 v[136:139], v[120:123], v[96:99], v[136:139]
    s_nop 5
    v_cvt_pk_bf16_f32 v156, v124, v128
    v_cvt_pk_bf16_f32 v157, v125, v129
    v_cvt_pk_bf16_f32 v158, v126, v130
    v_cvt_pk_bf16_f32 v159, v127, v131
    ds_write_b128 v172, v[156:159] offset:0
    v_cvt_pk_bf16_f32 v160, v132, v136
    v_cvt_pk_bf16_f32 v161, v133, v137
    v_cvt_pk_bf16_f32 v162, v134, v138
    v_cvt_pk_bf16_f32 v163, v135, v139
    ds_write_b128 v172, v[160:163] offset:1024
    v_mfma_f32_16x16x32_bf16 v[100:103], v[12:15], v[44:47], 0
    v_mfma_f32_16x16x32_bf16 v[104:107], v[12:15], v[48:51], 0
    v_mfma_f32_16x16x32_bf16 v[108:111], v[16:19], v[44:47], 0
    v_mfma_f32_16x16x32_bf16 v[112:115], v[16:19], v[48:51], 0
    s_nop 4
    v_mul_f32 v140, v100, v52
    v_mul_f32 v141, v104, v52
    v_mul_f32 v142, v101, v54
    v_mul_f32 v143, v105, v54
    v_mul_f32 v144, v102, v56
    v_mul_f32 v145, v106, v56
    v_mul_f32 v146, v103, v58
    v_mul_f32 v147, v107, v58
    v_fmac_f32 v140, v104, v53
    v_fma_f32 v141, -v100, v53, v141
    v_fmac_f32 v142, v105, v55
    v_fma_f32 v143, -v101, v55, v143
    v_fmac_f32 v144, v106, v57
    v_fma_f32 v145, -v102, v57, v145
    v_fmac_f32 v146, v107, v59
    v_fma_f32 v147, -v103, v59, v147
    v_cvt_pk_bf16_f32 v116, v140, v141
    v_cvt_pk_bf16_f32 v117, v142, v143
    v_cvt_pk_bf16_f32 v118, v144, v145
    v_cvt_pk_bf16_f32 v119, v146, v147
    v_mul_f32 v140, v108, v60
    v_mul_f32 v141, v112, v60
    v_mul_f32 v142, v109, v62
    v_mul_f32 v143, v113, v62
    v_mul_f32 v144, v110, v64
    v_mul_f32 v145, v114, v64
    v_mul_f32 v146, v111, v66
    v_mul_f32 v147, v115, v66
    v_fmac_f32 v140, v112, v61
    v_fma_f32 v141, -v108, v61, v141
    v_fmac_f32 v142, v113, v63
    v_fma_f32 v143, -v109, v63, v143
    v_fmac_f32 v144, v114, v65
    v_fma_f32 v145, -v110, v65, v145
    v_fmac_f32 v146, v115, v67
    v_fma_f32 v147, -v111, v67, v147
    v_cvt_pk_bf16_f32 v120, v140, v141
    v_cvt_pk_bf16_f32 v121, v142, v143
    v_cvt_pk_bf16_f32 v122, v144, v145
    v_cvt_pk_bf16_f32 v123, v146, v147
    v_mfma_f32_16x16x32_bf16 v[124:127], v[116:119], v[68:71], 0
    v_mfma_f32_16x16x32_bf16 v[128:131], v[116:119], v[72:75], 0
    v_mfma_f32_16x16x32_bf16 v[132:135], v[116:119], v[84:87], 0
    v_mfma_f32_16x16x32_bf16 v[136:139], v[116:119], v[88:91], 0
    v_mfma_f32_16x16x32_bf16 v[124:127], v[120:123], v[76:79], v[124:127]
    v_mfma_f32_16x16x32_bf16 v[128:131], v[120:123], v[80:83], v[128:131]
    v_mfma_f32_16x16x32_bf16 v[132:135], v[120:123], v[92:95], v[132:135]
    v_mfma_f32_16x16x32_bf16 v[136:139], v[120:123], v[96:99], v[136:139]
    s_nop 5
    v_cvt_pk_bf16_f32 v164, v124, v128
    v_cvt_pk_bf16_f32 v165, v125, v129
    v_cvt_pk_bf16_f32 v166, v126, v130
    v_cvt_pk_bf16_f32 v167, v127, v131
    ds_write_b128 v172, v[164:167] offset:8192
    v_cvt_pk_bf16_f32 v168, v132, v136
    v_cvt_pk_bf16_f32 v169, v133, v137
    v_cvt_pk_bf16_f32 v170, v134, v138
    v_cvt_pk_bf16_f32 v171, v135, v139
    ds_write_b128 v172, v[168:171] offset:9216
    s_waitcnt vmcnt(40)
    s_lshl_b32 s26, s28, 12
    s_add_u32 s26, s26, 94208
    v_lshl_add_u32 v238, v1, 6, s26
    v_lshl_add_u32 v239, v1, 4, s26
    v_lshrrev_b32 v240, 3, v1
    v_lshlrev_b32 v240, 15, v240
    v_and_b32 v236, 7, v1
    v_lshl_add_u32 v240, v236, 4, v240
    s_lshl_b32 s26, s68, 7
    s_add_u32 s26, s26, 20971520
    s_lshl_b32 s27, s28, 20
    s_add_u32 s27, s27, s26
    s_waitcnt vmcnt(8)
    v_lshl_or_b32 v196, v212, 16, v196
    v_lshl_or_b32 v197, v213, 16, v197
    v_lshl_or_b32 v198, v214, 16, v198
    v_lshl_or_b32 v199, v215, 16, v199
    v_lshl_or_b32 v200, v216, 16, v200
    v_lshl_or_b32 v201, v217, 16, v201
    v_lshl_or_b32 v202, v218, 16, v202
    v_lshl_or_b32 v203, v219, 16, v203
    v_lshl_or_b32 v204, v220, 16, v204
    v_lshl_or_b32 v205, v221, 16, v205
    v_lshl_or_b32 v206, v222, 16, v206
    v_lshl_or_b32 v207, v223, 16, v207
    v_lshl_or_b32 v208, v224, 16, v208
    v_lshl_or_b32 v209, v225, 16, v209
    v_lshl_or_b32 v210, v226, 16, v210
    v_lshl_or_b32 v211, v227, 16, v211
    ds_write_b128 v238, v[196:199] offset:0
    ds_write_b128 v238, v[200:203] offset:16
    ds_write_b128 v238, v[204:207] offset:32
    ds_write_b128 v238, v[208:211] offset:48
    s_waitcnt lgkmcnt(0)
    ds_read_b128 v[212:215], v239 offset:0
    ds_read_b128 v[216:219], v239 offset:1024
    ds_read_b128 v[220:223], v239 offset:2048
    ds_read_b128 v[224:227], v239 offset:3072
    s_waitcnt vmcnt(0)
    v_lshl_or_b32 v228, v232, 16, v228
    v_lshl_or_b32 v229, v233, 16, v229
    v_lshl_or_b32 v230, v234, 16, v230
    v_lshl_or_b32 v231, v235, 16, v231
    s_waitcnt lgkmcnt(3)
    buffer_store_dwordx4 v[212:215], v240, s[56:59], s27 offen sc1
    s_add_u32 s27, s27, 262144
    s_waitcnt lgkmcnt(2)
    buffer_store_dwordx4 v[216:219], v240, s[56:59], s27 offen sc1
    s_add_u32 s27, s27, 262144
    s_waitcnt lgkmcnt(1)
    buffer_store_dwordx4 v[220:223], v240, s[56:59], s27 offen sc1
    s_add_u32 s27, s27, 262144
    s_waitcnt lgkmcnt(0)
    buffer_store_dwordx4 v[224:227], v240, s[56:59], s27 offen sc1
    s_add_u32 s27, s27, 262144
    s_add_u32 s26, s26, 4194304
    s_cmp_eq_u32 s28, 0
    s_cselect_b64 exec, 0xff, 0
    s_cbranch_execz Lskip_1601
    buffer_store_dwordx4 v[228:231], v240, s[56:59], s26 offen sc1
Lskip_1601:
    s_mov_b64 exec, -1
    v_lshlrev_b32 v100, 16, v20
    v_and_b32 v101, 0xffff0000, v20
    v_lshlrev_b32 v102, 16, v21
    v_and_b32 v103, 0xffff0000, v21
    v_lshlrev_b32 v104, 16, v22
    v_and_b32 v105, 0xffff0000, v22
    v_lshlrev_b32 v106, 16, v23
    v_and_b32 v107, 0xffff0000, v23
    v_lshlrev_b32 v108, 16, v24
    v_and_b32 v109, 0xffff0000, v24
    v_lshlrev_b32 v110, 16, v25
    v_and_b32 v111, 0xffff0000, v25
    v_lshlrev_b32 v112, 16, v26
    v_and_b32 v113, 0xffff0000, v26
    v_lshlrev_b32 v114, 16, v27
    v_and_b32 v115, 0xffff0000, v27
    v_mov_b32 v41, 0x3f803f80
    v_lshlrev_b32 v140, 16, v4
    v_and_b32 v141, 0xffff0000, v4
    v_lshlrev_b32 v142, 16, v5
    v_and_b32 v143, 0xffff0000, v5
    v_lshlrev_b32 v144, 16, v6
    v_and_b32 v145, 0xffff0000, v6
    v_lshlrev_b32 v146, 16, v7
    v_and_b32 v147, 0xffff0000, v7
    v_lshlrev_b32 v148, 16, v8
    v_and_b32 v149, 0xffff0000, v8
    v_lshlrev_b32 v150, 16, v9
    v_and_b32 v151, 0xffff0000, v9
    v_lshlrev_b32 v152, 16, v10
    v_and_b32 v153, 0xffff0000, v10
    v_lshlrev_b32 v154, 16, v11
    v_and_b32 v155, 0xffff0000, v11
    v_pk_mul_f32 v[140:141], v[140:141], v[100:101]
    v_pk_mul_f32 v[142:143], v[142:143], v[102:103]
    v_pk_mul_f32 v[144:145], v[144:145], v[104:105]
    v_pk_mul_f32 v[146:147], v[146:147], v[106:107]
    v_pk_mul_f32 v[148:149], v[148:149], v[108:109]
    v_pk_mul_f32 v[150:151], v[150:151], v[110:111]
    v_pk_mul_f32 v[152:153], v[152:153], v[112:113]
    v_pk_mul_f32 v[154:155], v[154:155], v[114:115]
    v_cvt_pk_bf16_f32 v140, v140, v141
    v_cvt_pk_bf16_f32 v142, v142, v143
    v_cvt_pk_bf16_f32 v144, v144, v145
    v_cvt_pk_bf16_f32 v146, v146, v147
    v_cvt_pk_bf16_f32 v148, v148, v149
    v_cvt_pk_bf16_f32 v150, v150, v151
    v_cvt_pk_bf16_f32 v152, v152, v153
    v_cvt_pk_bf16_f32 v154, v154, v155
    v_mov_b32 v174, 0
    v_dot2_f32_bf16 v174, v140, v41, v174
    v_dot2_f32_bf16 v174, v142, v41, v174
    v_dot2_f32_bf16 v174, v144, v41, v174
    v_dot2_f32_bf16 v174, v146, v41, v174
    v_dot2_f32_bf16 v174, v148, v41, v174
    v_dot2_f32_bf16 v174, v150, v41, v174
    v_dot2_f32_bf16 v174, v152, v41, v174
    v_dot2_f32_bf16 v174, v154, v41, v174
    s_nop 2
    v_lshlrev_b32 v140, 16, v12
    v_and_b32 v141, 0xffff0000, v12
    v_lshlrev_b32 v142, 16, v13
    v_and_b32 v143, 0xffff0000, v13
    v_lshlrev_b32 v144, 16, v14
    v_and_b32 v145, 0xffff0000, v14
    v_lshlrev_b32 v146, 16, v15
    v_and_b32 v147, 0xffff0000, v15
    v_lshlrev_b32 v148, 16, v16
    v_and_b32 v149, 0xffff0000, v16
    v_lshlrev_b32 v150, 16, v17
    v_and_b32 v151, 0xffff0000, v17
    v_lshlrev_b32 v152, 16, v18
    v_and_b32 v153, 0xffff0000, v18
    v_lshlrev_b32 v154, 16, v19
    v_and_b32 v155, 0xffff0000, v19
    v_pk_mul_f32 v[140:141], v[140:141], v[100:101]
    v_pk_mul_f32 v[142:143], v[142:143], v[102:103]
    v_pk_mul_f32 v[144:145], v[144:145], v[104:105]
    v_pk_mul_f32 v[146:147], v[146:147], v[106:107]
    v_pk_mul_f32 v[148:149], v[148:149], v[108:109]
    v_pk_mul_f32 v[150:151], v[150:151], v[110:111]
    v_pk_mul_f32 v[152:153], v[152:153], v[112:113]
    v_pk_mul_f32 v[154:155], v[154:155], v[114:115]
    v_cvt_pk_bf16_f32 v140, v140, v141
    v_cvt_pk_bf16_f32 v142, v142, v143
    v_cvt_pk_bf16_f32 v144, v144, v145
    v_cvt_pk_bf16_f32 v146, v146, v147
    v_cvt_pk_bf16_f32 v148, v148, v149
    v_cvt_pk_bf16_f32 v150, v150, v151
    v_cvt_pk_bf16_f32 v152, v152, v153
    v_cvt_pk_bf16_f32 v154, v154, v155
    v_mov_b32 v175, 0
    v_dot2_f32_bf16 v175, v140, v41, v175
    v_dot2_f32_bf16 v175, v142, v41, v175
    v_dot2_f32_bf16 v175, v144, v41, v175
    v_dot2_f32_bf16 v175, v146, v41, v175
    v_dot2_f32_bf16 v175, v148, v41, v175
    v_dot2_f32_bf16 v175, v150, v41, v175
    v_dot2_f32_bf16 v175, v152, v41, v175
    v_dot2_f32_bf16 v175, v154, v41, v175
    s_nop 2
    v_add_f32_dpp v174, v174, v174 row_shr:1 bound_ctrl:0
    v_add_f32_dpp v175, v175, v175 row_shr:1 bound_ctrl:0
    s_nop 0
    v_add_f32_dpp v174, v174, v174 row_shr:2 bound_ctrl:0
    v_add_f32_dpp v175, v175, v175 row_shr:2 bound_ctrl:0
    s_nop 0
    v_add_f32_dpp v174, v174, v174 row_shr:4 bound_ctrl:0
    v_add_f32_dpp v175, v175, v175 row_shr:4 bound_ctrl:0
    s_nop 0
    v_add_f32_dpp v174, v174, v174 row_shr:8 bound_ctrl:0
    v_add_f32_dpp v175, v175, v175 row_shr:8 bound_ctrl:0
    s_nop 0
    v_add_f32_dpp v174, v174, v174 row_bcast:15 row_mask:0xa
    v_add_f32_dpp v175, v175, v175 row_bcast:15 row_mask:0xa
    s_nop 0
    v_add_f32_dpp v174, v174, v174 row_bcast:31 row_mask:0xc
    v_add_f32_dpp v175, v175, v175 row_bcast:31 row_mask:0xc
    v_cvt_pk_bf16_f32 v42, v174, v175
    v_lshlrev_b32 v174, 16, v42
    v_and_b32 v175, 0xffff0000, v42
    v_mul_f32 v174, 0xbfb8aa3b, v174
    v_mul_f32 v175, 0xbfb8aa3b, v175
    v_exp_f32 v174, v174
    v_exp_f32 v175, v175
    v_add_f32 v174, 1.0, v174
    v_add_f32 v175, 1.0, v175
    v_rcp_f32 v174, v174
    v_rcp_f32 v175, v175
    s_nop 0
    v_cvt_pk_bf16_f32 v42, v174, v175
    v_lshlrev_b32 v174, 16, v42
    v_and_b32 v175, 0xffff0000, v42
    s_lshl_b32 s6, s68, 2
    s_add_u32 s6, s6, s28
    s_lshl_b32 s6, s6, 7
    s_add_u32 s6, s6, 26214400
    v_mov_b32 v42, 0
    s_mov_b64 s[22:23], exec
    s_lshl_b64 exec, 1, 63
    buffer_store_dwordx2 v[174:175], v42, s[56:59], s6 offen sc1
    s_mov_b64 exec, s[22:23]
    v_lshrrev_b32 v176, 3, v1
    v_lshlrev_b32 v176, 15, v176
    v_and_b32 v42, 7, v1
    v_lshl_add_u32 v176, v42, 4, v176
    s_waitcnt lgkmcnt(0)
    v_mov_b32 v140, 151588
    v_mov_b32 v141, 1
    s_mov_b64 exec, 1
    ds_add_u32 v140, v141
Lcb_9:
    ds_read_b32 v141, v140
    s_waitcnt lgkmcnt(0)
    v_readfirstlane_b32 s7, v141
    s_nop 0
    s_cmp_ge_u32 s7, 4
    s_cbranch_scc0 Lcb_9
    s_mov_b64 exec, -1
    v_lshrrev_b32 v41, 2, v1
    s_lshl_b32 s6, s28, 6
    v_add_u32 v41, s6, v41
    v_sub_u32 v42, 512, v41
    v_and_b32 v43, 1, v1
    v_cmp_ne_u32 vcc, 0, v43
    s_nop 1
    v_cndmask_b32 v41, v41, v42, vcc
    v_mov_b32 v40, 64
    v_mov_b32 v42, -64
    v_cndmask_b32 v40, v40, v42, vcc
    v_lshlrev_b32 v41, 2, v41
    v_and_b32 v43, 2, v1
    v_lshlrev_b32 v43, 12, v43
    v_add_u32 v43, 77824, v43
    v_add_u32 v37, v41, v43
    v_mov_b32 v42, 1024
    v_cmp_eq_u32 vcc, 2048, v41
    s_nop 1
    v_cndmask_b32 v42, v41, v42, vcc
    v_add_u32 v36, v42, v43
    v_add_u32 v37, v40, v37
    v_add_u32 v38, v40, v37
    v_add_u32 v39, v40, v38
    ds_read2st64_b32 v[156:157], v36 offset0:0 offset1:8
    ds_read2st64_b32 v[158:159], v36 offset0:16 offset1:24
    ds_read2st64_b32 v[160:161], v37 offset0:0 offset1:8
    ds_read2st64_b32 v[162:163], v37 offset0:16 offset1:24
    ds_read2st64_b32 v[164:165], v38 offset0:0 offset1:8
    ds_read2st64_b32 v[166:167], v38 offset0:16 offset1:24
    ds_read2st64_b32 v[168:169], v39 offset0:0 offset1:8
    ds_read2st64_b32 v[170:171], v39 offset0:16 offset1:24
    s_lshl_b32 s5, s68, 7
    s_add_u32 s5, s5, 16777216
    s_lshl_b32 s6, s28, 20
    s_add_u32 s6, s6, s5
    s_waitcnt lgkmcnt(6)
    buffer_store_dwordx4 v[156:159], v176, s[56:59], s6 offen sc1
    s_add_u32 s6, s6, 262144
    s_waitcnt lgkmcnt(4)
    buffer_store_dwordx4 v[160:163], v176, s[56:59], s6 offen sc1
    s_add_u32 s6, s6, 262144
    s_waitcnt lgkmcnt(2)
    buffer_store_dwordx4 v[164:167], v176, s[56:59], s6 offen sc1
    s_add_u32 s6, s6, 262144
    s_waitcnt lgkmcnt(0)
    buffer_store_dwordx4 v[168:171], v176, s[56:59], s6 offen sc1
    s_add_u32 s6, s6, 262144
Lgrpd_7:
    s_waitcnt lgkmcnt(0)
    s_barrier
LnoRF_3:
    s_cmp_lg_u32 s69, 0
    s_cbranch_scc1 Lload_2
    v_mov_b32 v2, 0
    s_mov_b64 exec, 1
    buffer_store_dword v2, v2, s[56:59], s100 offen sc1
    buffer_store_dword v2, v2, s[56:59], s101 offen sc1
    s_nop 0
    s_mov_b64 exec, -1

    s_mov_b32 s60, s42
    s_mov_b32 s61, s43
    s_mov_b32 s62, 7168
    s_mov_b32 s63, 0x20000
    s_lshr_b32 s3, s28, 1
    s_lshl_b32 s4, s3, 7
    s_add_u32 s4, s4, s30
    s_lshl_b32 s4, s4, 1
    s_lshl_b32 s5, s3, 4
    s_add_u32 s5, s5, s30
    s_add_u32 s5, s5, 96
    s_lshl_b32 s5, s5, 1
    v_lshrrev_b32 v2, 4, v1
    v_lshlrev_b32 v2, 3, v2

    buffer_load_dwordx2 v[242:243], v2, s[60:63], s4 offen offset:0
    buffer_load_dwordx2 v[244:245], v2, s[60:63], s4 offen offset:32
    buffer_load_dwordx2 v[246:247], v2, s[60:63], s4 offen offset:64
    buffer_load_dwordx2 v[248:249], v2, s[60:63], s4 offen offset:96
    buffer_load_dwordx2 v[250:251], v2, s[60:63], s4 offen offset:128
    buffer_load_dwordx2 v[252:253], v2, s[60:63], s4 offen offset:160
    buffer_load_dwordx2 v[254:255], v2, s[60:63], s5 offen
    s_lshr_b32 s24, s2, 1
    s_lshl_b32 s24, s24, 2
    s_add_u32 s24, s24, s28
    s_mul_i32 s25, s24, 896
    s_bitcmp1_b32 s2, 0
    s_cselect_b32 s8, s44, s40
    s_cselect_b32 s9, s45, s41
    s_mov_b32 s27, 0
    s_cselect_b32 s26, s27, 1376256
    s_add_u32 s25, s25, s26
    s_mov_b32 s10, 7340032
    s_mov_b32 s11, 0x20000
    v_lshlrev_b32 v240, 7, v1
    v_mov_b32 v241, 0x7fffff00
    v_cmp_gt_u32 vcc, 7, v1
    s_nop 1
    v_cndmask_b32 v240, v241, v240, vcc

    s_bitcmp1_b32 s2, 0
    s_cbranch_scc1 Lxpf_10
    s_lshr_b32 s3, s2, 3
    s_lshl_b32 s3, s3, 2
    s_add_u32 s3, s3, s28
    s_lshr_b32 s25, s3, 1
    s_mul_i32 s25, s25, 7168
    s_bfe_u32 s5, s2, 0x20001
    s_mul_i32 s5, s5, 1792
    s_add_u32 s25, s25, s5
    s_and_b32 s5, s3, 1
    s_mul_i32 s5, s5, 896
    s_add_u32 s25, s25, s5
    s_add_u32 s25, s25, 1376256

Lxpf_10:
    s_and_b32 s70, s28, 1
    s_mul_i32 s70, s70, 8192
    v_and_b32 v216, 15, v1
    v_lshlrev_b32 v208, 7, v216
    v_lshrrev_b32 v216, 1, v216
    v_lshrrev_b32 v217, 4, v1
    v_xor_b32 v216, v216, v217
    v_lshlrev_b32 v216, 4, v216
    v_add3_u32 v208, v208, v216, s70
    v_xor_b32 v209, 64, v208
    s_lshr_b32 s70, s28, 1
    s_mul_i32 s71, s70, 7
    v_lshrrev_b32 v216, 4, v1
    v_lshlrev_b32 v216, 3, v216
    v_bfe_u32 v217, v1, 2, 2
    v_add_u32 v216, v216, v217
    v_lshrrev_b32 v217, 2, v216
    v_and_b32 v217, 2, v217
    s_lshl_b32 s72, s70, 3
    s_add_u32 s72, s72, 0
    s_lshl_b32 s72, s72, 1
    v_xor_b32 v217, s72, v217
    v_bfe_u32 v210, v1, 1, 1
    v_or_b32 v217, v217, v210
    v_lshlrev_b32 v217, 4, v217
    v_mul_u32_u24 v210, 448, v216
    v_add_u32 v210, v210, v217
    v_and_b32 v217, 1, v1
    v_lshlrev_b32 v217, 3, v217
    v_add_u32 v210, v210, v217
    v_add_u32 v210, 16384, v210
    v_lshrrev_b32 v217, 2, v216
    v_and_b32 v217, 2, v217
    s_lshl_b32 s72, s70, 3
    s_add_u32 s72, s72, 1
    s_lshl_b32 s72, s72, 1
    v_xor_b32 v217, s72, v217
    v_bfe_u32 v211, v1, 1, 1
    v_or_b32 v217, v217, v211
    v_lshlrev_b32 v217, 4, v217
    v_mul_u32_u24 v211, 448, v216
    v_add_u32 v211, v211, v217
    v_and_b32 v217, 1, v1
    v_lshlrev_b32 v217, 3, v217
    v_add_u32 v211, v211, v217
    v_add_u32 v211, 16384, v211
    v_lshrrev_b32 v217, 2, v216
    v_and_b32 v217, 2, v217
    s_add_u32 s72, s70, 6
    s_lshl_b32 s72, s72, 1
    v_xor_b32 v217, s72, v217
    v_bfe_u32 v212, v1, 1, 1
    v_or_b32 v217, v217, v212
    v_lshlrev_b32 v217, 4, v217
    v_mul_u32_u24 v212, 448, v216
    v_add_u32 v212, v212, v217
    v_and_b32 v217, 1, v1
    v_lshlrev_b32 v217, 3, v217
    v_add_u32 v212, v212, v217
    v_add_u32 v212, 16384, v212
    s_mov_b32 s18, 0
    s_waitcnt vmcnt(0)
    buffer_load_dword v241, v240, s[8:11], s25 offen
    s_add_u32 s25, s25, 458752
    buffer_load_dword v241, v240, s[8:11], s25 offen
    s_add_u32 s25, s25, 458752
    buffer_load_dword v241, v240, s[8:11], s25 offen
    s_add_u32 s25, s25, 458752
    buffer_load_dword v241, v240, s[8:11], s25 offen
    s_add_u32 s25, s25, 458752
    buffer_load_dword v241, v240, s[8:11], s25 offen
    s_add_u32 s25, s25, 458752
    buffer_load_dword v241, v240, s[8:11], s25 offen
    s_add_u32 s25, s25, 458752
    buffer_load_dword v241, v240, s[8:11], s25 offen
    s_add_u32 s25, s25, 458752
    buffer_load_dword v241, v240, s[8:11], s25 offen
    s_add_u32 s25, s25, 458752
    buffer_load_dword v241, v240, s[8:11], s25 offen
    s_add_u32 s25, s25, 458752
    buffer_load_dword v241, v240, s[8:11], s25 offen
    s_add_u32 s25, s25, 458752
    buffer_load_dword v241, v240, s[8:11], s25 offen
    s_add_u32 s25, s25, 458752
    buffer_load_dword v241, v240, s[8:11], s25 offen
    s_add_u32 s25, s25, 458752
    buffer_load_dword v241, v240, s[8:11], s25 offen
    s_add_u32 s25, s25, 458752
    buffer_load_dword v241, v240, s[8:11], s25 offen
    s_add_u32 s25, s25, 458752
    buffer_load_dword v241, v240, s[8:11], s25 offen
    s_add_u32 s25, s25, 458752
    buffer_load_dword v241, v240, s[8:11], s25 offen
    s_add_u32 s25, s25, 458752
Lskpf_11:
    v_lshlrev_b32 v8, 16, v242
    v_and_b32 v9, 0xffff0000, v242
    v_lshlrev_b32 v10, 16, v243
    v_and_b32 v11, 0xffff0000, v243
    v_lshlrev_b32 v36, 16, v242
    v_and_b32 v37, 0xffff0000, v242
    v_lshlrev_b32 v38, 16, v243
    v_and_b32 v39, 0xffff0000, v243
    v_lshlrev_b32 v64, 16, v242
    v_and_b32 v65, 0xffff0000, v242
    v_lshlrev_b32 v66, 16, v243
    v_and_b32 v67, 0xffff0000, v243
    v_lshlrev_b32 v92, 16, v242
    v_and_b32 v93, 0xffff0000, v242
    v_lshlrev_b32 v94, 16, v243
    v_and_b32 v95, 0xffff0000, v243
    v_lshlrev_b32 v12, 16, v244
    v_and_b32 v13, 0xffff0000, v244
    v_lshlrev_b32 v14, 16, v245
    v_and_b32 v15, 0xffff0000, v245
    v_lshlrev_b32 v40, 16, v244
    v_and_b32 v41, 0xffff0000, v244
    v_lshlrev_b32 v42, 16, v245
    v_and_b32 v43, 0xffff0000, v245
    v_lshlrev_b32 v68, 16, v244
    v_and_b32 v69, 0xffff0000, v244
    v_lshlrev_b32 v70, 16, v245
    v_and_b32 v71, 0xffff0000, v245
    v_lshlrev_b32 v96, 16, v244
    v_and_b32 v97, 0xffff0000, v244
    v_lshlrev_b32 v98, 16, v245
    v_and_b32 v99, 0xffff0000, v245
    v_lshlrev_b32 v16, 16, v246
    v_and_b32 v17, 0xffff0000, v246
    v_lshlrev_b32 v18, 16, v247
    v_and_b32 v19, 0xffff0000, v247
    v_lshlrev_b32 v44, 16, v246
    v_and_b32 v45, 0xffff0000, v246
    v_lshlrev_b32 v46, 16, v247
    v_and_b32 v47, 0xffff0000, v247
    v_lshlrev_b32 v72, 16, v246
    v_and_b32 v73, 0xffff0000, v246
    v_lshlrev_b32 v74, 16, v247
    v_and_b32 v75, 0xffff0000, v247
    v_lshlrev_b32 v100, 16, v246
    v_and_b32 v101, 0xffff0000, v246
    v_lshlrev_b32 v102, 16, v247
    v_and_b32 v103, 0xffff0000, v247
    v_lshlrev_b32 v20, 16, v248
    v_and_b32 v21, 0xffff0000, v248
    v_lshlrev_b32 v22, 16, v249
    v_and_b32 v23, 0xffff0000, v249
    v_lshlrev_b32 v48, 16, v248
    v_and_b32 v49, 0xffff0000, v248
    v_lshlrev_b32 v50, 16, v249
    v_and_b32 v51, 0xffff0000, v249
    v_lshlrev_b32 v76, 16, v248
    v_and_b32 v77, 0xffff0000, v248
    v_lshlrev_b32 v78, 16, v249
    v_and_b32 v79, 0xffff0000, v249
    v_lshlrev_b32 v104, 16, v248
    v_and_b32 v105, 0xffff0000, v248
    v_lshlrev_b32 v106, 16, v249
    v_and_b32 v107, 0xffff0000, v249
    v_lshlrev_b32 v24, 16, v250
    v_and_b32 v25, 0xffff0000, v250
    v_lshlrev_b32 v26, 16, v251
    v_and_b32 v27, 0xffff0000, v251
    v_lshlrev_b32 v52, 16, v250
    v_and_b32 v53, 0xffff0000, v250
    v_lshlrev_b32 v54, 16, v251
    v_and_b32 v55, 0xffff0000, v251
    v_lshlrev_b32 v80, 16, v250
    v_and_b32 v81, 0xffff0000, v250
    v_lshlrev_b32 v82, 16, v251
    v_and_b32 v83, 0xffff0000, v251
    v_lshlrev_b32 v108, 16, v250
    v_and_b32 v109, 0xffff0000, v250
    v_lshlrev_b32 v110, 16, v251
    v_and_b32 v111, 0xffff0000, v251
    v_lshlrev_b32 v28, 16, v252
    v_and_b32 v29, 0xffff0000, v252
    v_lshlrev_b32 v30, 16, v253
    v_and_b32 v31, 0xffff0000, v253
    v_lshlrev_b32 v56, 16, v252
    v_and_b32 v57, 0xffff0000, v252
    v_lshlrev_b32 v58, 16, v253
    v_and_b32 v59, 0xffff0000, v253
    v_lshlrev_b32 v84, 16, v252
    v_and_b32 v85, 0xffff0000, v252
    v_lshlrev_b32 v86, 16, v253
    v_and_b32 v87, 0xffff0000, v253
    v_lshlrev_b32 v112, 16, v252
    v_and_b32 v113, 0xffff0000, v252
    v_lshlrev_b32 v114, 16, v253
    v_and_b32 v115, 0xffff0000, v253
    v_lshlrev_b32 v32, 16, v254
    v_and_b32 v33, 0xffff0000, v254
    v_lshlrev_b32 v34, 16, v255
    v_and_b32 v35, 0xffff0000, v255
    v_lshlrev_b32 v60, 16, v254
    v_and_b32 v61, 0xffff0000, v254
    v_lshlrev_b32 v62, 16, v255
    v_and_b32 v63, 0xffff0000, v255
    v_lshlrev_b32 v88, 16, v254
    v_and_b32 v89, 0xffff0000, v254
    v_lshlrev_b32 v90, 16, v255
    v_and_b32 v91, 0xffff0000, v255
    v_lshlrev_b32 v116, 16, v254
    v_and_b32 v117, 0xffff0000, v254
    v_lshlrev_b32 v118, 16, v255
    v_and_b32 v119, 0xffff0000, v255
    s_mov_b32 s76, 4294877184
    s_mov_b32 s77, 45056
    s_barrier
    ds_read_b64_tr_b16 v[152:153], v210 offset:0
    ds_read_b64_tr_b16 v[154:155], v210 offset:1792
    ds_read_b128 v[120:123], v208 offset:0
    ds_read_b128 v[124:127], v208 offset:2048
    ds_read_b128 v[128:131], v208 offset:4096
    ds_read_b128 v[132:135], v208 offset:6144
    ds_read_b64_tr_b16 v[156:157], v211 offset:0
    ds_read_b64_tr_b16 v[158:159], v211 offset:1792
    ds_read_b64_tr_b16 v[160:161], v210 offset:64
    ds_read_b64_tr_b16 v[162:163], v210 offset:1856
    ds_read_b64_tr_b16 v[164:165], v211 offset:64
    ds_read_b64_tr_b16 v[166:167], v211 offset:1856
    ds_read_b64_tr_b16 v[168:169], v210 offset:128
    ds_read_b64_tr_b16 v[170:171], v210 offset:1920
    ds_read_b64_tr_b16 v[172:173], v211 offset:128
    ds_read_b64_tr_b16 v[174:175], v211 offset:1920
    ds_read_b64_tr_b16 v[176:177], v212 offset:0
    ds_read_b64_tr_b16 v[178:179], v212 offset:1792
    s_waitcnt lgkmcnt(0)
    s_mov_b32 s19, 15
.p2align 6
Lcons_12:
    v_mfma_f32_16x16x32_bf16 v[8:11], v[152:155], v[120:123], v[8:11]
    ds_read_b64_tr_b16 v[180:181], v210 offset:14336
    v_mfma_f32_16x16x32_bf16 v[36:39], v[152:155], v[124:127], v[36:39]
    ds_read_b64_tr_b16 v[182:183], v210 offset:16128
    v_mfma_f32_16x16x32_bf16 v[64:67], v[152:155], v[128:131], v[64:67]
    ds_read_b128 v[136:139], v209 offset:0
    v_mfma_f32_16x16x32_bf16 v[92:95], v[152:155], v[132:135], v[92:95]
    ds_read_b128 v[140:143], v209 offset:2048
    v_mfma_f32_16x16x32_bf16 v[12:15], v[156:159], v[120:123], v[12:15]
    ds_read_b128 v[144:147], v209 offset:4096
    v_mfma_f32_16x16x32_bf16 v[40:43], v[156:159], v[124:127], v[40:43]
    ds_read_b128 v[148:151], v209 offset:6144
    v_mfma_f32_16x16x32_bf16 v[68:71], v[156:159], v[128:131], v[68:71]
    ds_read_b64_tr_b16 v[184:185], v211 offset:14336
    v_mfma_f32_16x16x32_bf16 v[96:99], v[156:159], v[132:135], v[96:99]
    ds_read_b64_tr_b16 v[186:187], v211 offset:16128
    v_mfma_f32_16x16x32_bf16 v[16:19], v[160:163], v[120:123], v[16:19]
    ds_read_b64_tr_b16 v[188:189], v210 offset:14400
    v_mfma_f32_16x16x32_bf16 v[44:47], v[160:163], v[124:127], v[44:47]
    ds_read_b64_tr_b16 v[190:191], v210 offset:16192
    v_mfma_f32_16x16x32_bf16 v[72:75], v[160:163], v[128:131], v[72:75]
    ds_read_b64_tr_b16 v[192:193], v211 offset:14400
    v_mfma_f32_16x16x32_bf16 v[100:103], v[160:163], v[132:135], v[100:103]
    ds_read_b64_tr_b16 v[194:195], v211 offset:16192
    v_mfma_f32_16x16x32_bf16 v[20:23], v[164:167], v[120:123], v[20:23]
    ds_read_b64_tr_b16 v[196:197], v210 offset:14464
    v_mfma_f32_16x16x32_bf16 v[48:51], v[164:167], v[124:127], v[48:51]
    ds_read_b64_tr_b16 v[198:199], v210 offset:16256
    v_mfma_f32_16x16x32_bf16 v[76:79], v[164:167], v[128:131], v[76:79]
    ds_read_b64_tr_b16 v[200:201], v211 offset:14464
    v_mfma_f32_16x16x32_bf16 v[104:107], v[164:167], v[132:135], v[104:107]
    ds_read_b64_tr_b16 v[202:203], v211 offset:16256
    v_mfma_f32_16x16x32_bf16 v[24:27], v[168:171], v[120:123], v[24:27]
    ds_read_b64_tr_b16 v[204:205], v212 offset:14336
    v_mfma_f32_16x16x32_bf16 v[52:55], v[168:171], v[124:127], v[52:55]
    ds_read_b64_tr_b16 v[206:207], v212 offset:16128
    v_mfma_f32_16x16x32_bf16 v[80:83], v[168:171], v[128:131], v[80:83]
    s_add_u32 s18, s18, 45056
    v_mfma_f32_16x16x32_bf16 v[108:111], v[168:171], v[132:135], v[108:111]
    s_cmp_eq_u32 s18, 135168
    v_mfma_f32_16x16x32_bf16 v[28:31], v[172:175], v[120:123], v[28:31]
    s_cselect_b32 s70, s76, s77
    v_mfma_f32_16x16x32_bf16 v[56:59], v[172:175], v[124:127], v[56:59]
    s_cselect_b32 s18, 0, s18
    v_mfma_f32_16x16x32_bf16 v[84:87], v[172:175], v[128:131], v[84:87]
    v_add_u32 v208, s70, v208
    v_mfma_f32_16x16x32_bf16 v[112:115], v[172:175], v[132:135], v[112:115]
    v_add_u32 v209, s70, v209
    v_mfma_f32_16x16x32_bf16 v[32:35], v[176:179], v[120:123], v[32:35]
    v_add_u32 v210, s70, v210
    v_mfma_f32_16x16x32_bf16 v[60:63], v[176:179], v[124:127], v[60:63]
    v_add_u32 v211, s70, v211
    v_add_u32 v212, s70, v212
    s_waitcnt lgkmcnt(0)
    s_barrier
    v_mfma_f32_16x16x32_bf16 v[88:91], v[176:179], v[128:131], v[88:91]
    v_mfma_f32_16x16x32_bf16 v[116:119], v[176:179], v[132:135], v[116:119]
    v_mfma_f32_16x16x32_bf16 v[8:11], v[180:183], v[136:139], v[8:11]
    ds_read_b64_tr_b16 v[152:153], v210 offset:0
    v_mfma_f32_16x16x32_bf16 v[36:39], v[180:183], v[140:143], v[36:39]
    ds_read_b64_tr_b16 v[154:155], v210 offset:1792
    v_mfma_f32_16x16x32_bf16 v[64:67], v[180:183], v[144:147], v[64:67]
    ds_read_b128 v[120:123], v208 offset:0
    v_mfma_f32_16x16x32_bf16 v[92:95], v[180:183], v[148:151], v[92:95]
    ds_read_b128 v[124:127], v208 offset:2048
    v_mfma_f32_16x16x32_bf16 v[12:15], v[184:187], v[136:139], v[12:15]
    ds_read_b128 v[128:131], v208 offset:4096
    v_mfma_f32_16x16x32_bf16 v[40:43], v[184:187], v[140:143], v[40:43]
    ds_read_b128 v[132:135], v208 offset:6144
    v_mfma_f32_16x16x32_bf16 v[68:71], v[184:187], v[144:147], v[68:71]
    ds_read_b64_tr_b16 v[156:157], v211 offset:0
    v_mfma_f32_16x16x32_bf16 v[96:99], v[184:187], v[148:151], v[96:99]
    ds_read_b64_tr_b16 v[158:159], v211 offset:1792
    v_mfma_f32_16x16x32_bf16 v[16:19], v[188:191], v[136:139], v[16:19]
    ds_read_b64_tr_b16 v[160:161], v210 offset:64
    v_mfma_f32_16x16x32_bf16 v[44:47], v[188:191], v[140:143], v[44:47]
    ds_read_b64_tr_b16 v[162:163], v210 offset:1856
    v_mfma_f32_16x16x32_bf16 v[72:75], v[188:191], v[144:147], v[72:75]
    ds_read_b64_tr_b16 v[164:165], v211 offset:64
    v_mfma_f32_16x16x32_bf16 v[100:103], v[188:191], v[148:151], v[100:103]
    ds_read_b64_tr_b16 v[166:167], v211 offset:1856
    v_mfma_f32_16x16x32_bf16 v[20:23], v[192:195], v[136:139], v[20:23]
    ds_read_b64_tr_b16 v[168:169], v210 offset:128
    v_mfma_f32_16x16x32_bf16 v[48:51], v[192:195], v[140:143], v[48:51]
    ds_read_b64_tr_b16 v[170:171], v210 offset:1920
    v_mfma_f32_16x16x32_bf16 v[76:79], v[192:195], v[144:147], v[76:79]
    ds_read_b64_tr_b16 v[172:173], v211 offset:128
    v_mfma_f32_16x16x32_bf16 v[104:107], v[192:195], v[148:151], v[104:107]
    ds_read_b64_tr_b16 v[174:175], v211 offset:1920
    v_mfma_f32_16x16x32_bf16 v[24:27], v[196:199], v[136:139], v[24:27]
    ds_read_b64_tr_b16 v[176:177], v212 offset:0
    v_mfma_f32_16x16x32_bf16 v[52:55], v[196:199], v[140:143], v[52:55]
    ds_read_b64_tr_b16 v[178:179], v212 offset:1792
    v_mfma_f32_16x16x32_bf16 v[80:83], v[196:199], v[144:147], v[80:83]
    s_sub_u32 s19, s19, 1
    v_mfma_f32_16x16x32_bf16 v[108:111], v[196:199], v[148:151], v[108:111]
    s_cmp_lg_u32 s19, 0
    v_mfma_f32_16x16x32_bf16 v[28:31], v[200:203], v[136:139], v[28:31]
    v_mfma_f32_16x16x32_bf16 v[56:59], v[200:203], v[140:143], v[56:59]
    v_mfma_f32_16x16x32_bf16 v[84:87], v[200:203], v[144:147], v[84:87]
    v_mfma_f32_16x16x32_bf16 v[112:115], v[200:203], v[148:151], v[112:115]
    v_mfma_f32_16x16x32_bf16 v[32:35], v[204:207], v[136:139], v[32:35]
    v_mfma_f32_16x16x32_bf16 v[60:63], v[204:207], v[140:143], v[60:63]
    v_mfma_f32_16x16x32_bf16 v[88:91], v[204:207], v[144:147], v[88:91]
    v_mfma_f32_16x16x32_bf16 v[116:119], v[204:207], v[148:151], v[116:119]
    s_waitcnt lgkmcnt(0)
    s_cbranch_scc1 Lcons_12
    v_mfma_f32_16x16x32_bf16 v[8:11], v[152:155], v[120:123], v[8:11]
    ds_read_b64_tr_b16 v[180:181], v210 offset:14336
    v_mfma_f32_16x16x32_bf16 v[36:39], v[152:155], v[124:127], v[36:39]
    ds_read_b64_tr_b16 v[182:183], v210 offset:16128
    v_mfma_f32_16x16x32_bf16 v[64:67], v[152:155], v[128:131], v[64:67]
    ds_read_b128 v[136:139], v209 offset:0
    v_mfma_f32_16x16x32_bf16 v[92:95], v[152:155], v[132:135], v[92:95]
    ds_read_b128 v[140:143], v209 offset:2048
    v_mfma_f32_16x16x32_bf16 v[12:15], v[156:159], v[120:123], v[12:15]
    ds_read_b128 v[144:147], v209 offset:4096
    v_mfma_f32_16x16x32_bf16 v[40:43], v[156:159], v[124:127], v[40:43]
    ds_read_b128 v[148:151], v209 offset:6144
    v_mfma_f32_16x16x32_bf16 v[68:71], v[156:159], v[128:131], v[68:71]
    ds_read_b64_tr_b16 v[184:185], v211 offset:14336
    v_mfma_f32_16x16x32_bf16 v[96:99], v[156:159], v[132:135], v[96:99]
    ds_read_b64_tr_b16 v[186:187], v211 offset:16128
    v_mfma_f32_16x16x32_bf16 v[16:19], v[160:163], v[120:123], v[16:19]
    ds_read_b64_tr_b16 v[188:189], v210 offset:14400
    v_mfma_f32_16x16x32_bf16 v[44:47], v[160:163], v[124:127], v[44:47]
    ds_read_b64_tr_b16 v[190:191], v210 offset:16192
    v_mfma_f32_16x16x32_bf16 v[72:75], v[160:163], v[128:131], v[72:75]
    ds_read_b64_tr_b16 v[192:193], v211 offset:14400
    v_mfma_f32_16x16x32_bf16 v[100:103], v[160:163], v[132:135], v[100:103]
    ds_read_b64_tr_b16 v[194:195], v211 offset:16192
    v_mfma_f32_16x16x32_bf16 v[20:23], v[164:167], v[120:123], v[20:23]
    ds_read_b64_tr_b16 v[196:197], v210 offset:14464
    v_mfma_f32_16x16x32_bf16 v[48:51], v[164:167], v[124:127], v[48:51]
    ds_read_b64_tr_b16 v[198:199], v210 offset:16256
    v_mfma_f32_16x16x32_bf16 v[76:79], v[164:167], v[128:131], v[76:79]
    ds_read_b64_tr_b16 v[200:201], v211 offset:14464
    v_mfma_f32_16x16x32_bf16 v[104:107], v[164:167], v[132:135], v[104:107]
    ds_read_b64_tr_b16 v[202:203], v211 offset:16256
    v_mfma_f32_16x16x32_bf16 v[24:27], v[168:171], v[120:123], v[24:27]
    ds_read_b64_tr_b16 v[204:205], v212 offset:14336
    v_mfma_f32_16x16x32_bf16 v[52:55], v[168:171], v[124:127], v[52:55]
    ds_read_b64_tr_b16 v[206:207], v212 offset:16128
    v_mfma_f32_16x16x32_bf16 v[80:83], v[168:171], v[128:131], v[80:83]
    v_mfma_f32_16x16x32_bf16 v[108:111], v[168:171], v[132:135], v[108:111]
    v_mfma_f32_16x16x32_bf16 v[28:31], v[172:175], v[120:123], v[28:31]
    v_mfma_f32_16x16x32_bf16 v[56:59], v[172:175], v[124:127], v[56:59]
    v_mfma_f32_16x16x32_bf16 v[84:87], v[172:175], v[128:131], v[84:87]
    v_mfma_f32_16x16x32_bf16 v[112:115], v[172:175], v[132:135], v[112:115]
    v_mfma_f32_16x16x32_bf16 v[32:35], v[176:179], v[120:123], v[32:35]
    v_mfma_f32_16x16x32_bf16 v[60:63], v[176:179], v[124:127], v[60:63]
    s_waitcnt lgkmcnt(0)
    s_barrier
    v_mfma_f32_16x16x32_bf16 v[88:91], v[176:179], v[128:131], v[88:91]
    v_mfma_f32_16x16x32_bf16 v[116:119], v[176:179], v[132:135], v[116:119]
    v_mfma_f32_16x16x32_bf16 v[8:11], v[180:183], v[136:139], v[8:11]
    v_mfma_f32_16x16x32_bf16 v[36:39], v[180:183], v[140:143], v[36:39]
    v_mfma_f32_16x16x32_bf16 v[64:67], v[180:183], v[144:147], v[64:67]
    v_mfma_f32_16x16x32_bf16 v[92:95], v[180:183], v[148:151], v[92:95]
    v_mfma_f32_16x16x32_bf16 v[12:15], v[184:187], v[136:139], v[12:15]
    v_mfma_f32_16x16x32_bf16 v[40:43], v[184:187], v[140:143], v[40:43]
    v_mfma_f32_16x16x32_bf16 v[68:71], v[184:187], v[144:147], v[68:71]
    v_mfma_f32_16x16x32_bf16 v[96:99], v[184:187], v[148:151], v[96:99]
    v_mov_b32 v216, 0xc0135761
    v_mov_b32 v217, 0xc0135761
    v_mov_b32 v218, 0xbdd2d3e8
    v_mov_b32 v219, 0xbdd2d3e8
    v_mov_b32 v220, 1.0
    v_mov_b32 v221, 1.0
    s_lshr_b32 s3, s28, 1
    s_and_b32 s4, s28, 1
    s_lshl_b32 s4, s4, 2
    s_lshr_b32 s5, s29, 4
    s_add_u32 s4, s4, s5
    s_mul_i32 s4, s4, 112
    s_lshr_b32 s5, s30, 5
    s_add_u32 s4, s4, s5
    s_lshl_b32 s4, s4, 10
    s_add_u32 s4, s4, 1048576
    s_lshl_b32 s6, s3, 12
    s_add_u32 s6, s6, s4
    s_lshl_b32 s7, s3, 5
    s_add_u32 s7, s7, s4
    s_add_u32 s7, s7, 3072
    v_and_b32 v4, 15, v1
    v_lshlrev_b32 v4, 6, v4
    v_lshrrev_b32 v5, 4, v1
    v_lshlrev_b32 v3, 3, v5
    v_add3_u32 v3, v3, v4, s7
    v_and_b32 v2, 1, v5
    v_lshlrev_b32 v2, 5, v2
    v_lshrrev_b32 v5, 1, v5
    v_lshlrev_b32 v5, 4, v5
    v_add3_u32 v2, v2, v5, v4
    v_add_u32 v2, s6, v2

    s_mov_b32 s20, 0
    s_mov_b32 s21, 114688
    s_mov_b32 s22, 229376
    s_mov_b32 s23, 344064
    v_pk_mul_f32 v[120:121], v[8:9], v[8:9]
    v_pk_mul_f32 v[122:123], v[10:11], v[10:11]
    v_pk_mul_f32 v[124:125], v[12:13], v[12:13]
    v_pk_mul_f32 v[126:127], v[14:15], v[14:15]
    v_mfma_f32_16x16x32_bf16 v[16:19], v[188:191], v[136:139], v[16:19]
    v_pk_fma_f32 v[120:121], v[120:121], v[218:219], v[216:217]
    v_pk_fma_f32 v[122:123], v[122:123], v[218:219], v[216:217]
    v_pk_fma_f32 v[124:125], v[124:125], v[218:219], v[216:217]
    v_pk_fma_f32 v[126:127], v[126:127], v[218:219], v[216:217]
    v_mfma_f32_16x16x32_bf16 v[44:47], v[188:191], v[140:143], v[44:47]
    v_pk_mul_f32 v[120:121], v[120:121], v[8:9]
    v_pk_mul_f32 v[122:123], v[122:123], v[10:11]
    v_pk_mul_f32 v[124:125], v[124:125], v[12:13]
    v_pk_mul_f32 v[126:127], v[126:127], v[14:15]
    v_mfma_f32_16x16x32_bf16 v[72:75], v[188:191], v[144:147], v[72:75]
    v_exp_f32 v120, v120
    v_exp_f32 v121, v121
    v_exp_f32 v122, v122
    v_exp_f32 v123, v123
    v_mfma_f32_16x16x32_bf16 v[100:103], v[188:191], v[148:151], v[100:103]
    v_exp_f32 v124, v124
    v_exp_f32 v125, v125
    v_exp_f32 v126, v126
    v_exp_f32 v127, v127
    v_mfma_f32_16x16x32_bf16 v[20:23], v[192:195], v[136:139], v[20:23]
    v_pk_add_f32 v[120:121], v[120:121], v[220:221]
    v_pk_add_f32 v[122:123], v[122:123], v[220:221]
    v_pk_add_f32 v[124:125], v[124:125], v[220:221]
    v_pk_add_f32 v[126:127], v[126:127], v[220:221]
    v_mfma_f32_16x16x32_bf16 v[48:51], v[192:195], v[140:143], v[48:51]
    v_rcp_f32 v120, v120
    v_rcp_f32 v121, v121
    v_rcp_f32 v122, v122
    v_rcp_f32 v123, v123
    v_mfma_f32_16x16x32_bf16 v[76:79], v[192:195], v[144:147], v[76:79]
    v_rcp_f32 v124, v124
    v_rcp_f32 v125, v125
    v_rcp_f32 v126, v126
    v_rcp_f32 v127, v127
    v_mfma_f32_16x16x32_bf16 v[104:107], v[192:195], v[148:151], v[104:107]
    v_pk_mul_f32 v[8:9], v[120:121], v[8:9]
    v_pk_mul_f32 v[10:11], v[122:123], v[10:11]
    v_pk_mul_f32 v[12:13], v[124:125], v[12:13]
    v_pk_mul_f32 v[14:15], v[126:127], v[14:15]
    v_mfma_f32_16x16x32_bf16 v[24:27], v[196:199], v[136:139], v[24:27]
    v_cvt_pk_bf16_f32 v152, v8, v9
    v_cvt_pk_bf16_f32 v153, v10, v11
    v_cvt_pk_bf16_f32 v154, v12, v13
    v_cvt_pk_bf16_f32 v155, v14, v15
    v_mfma_f32_16x16x32_bf16 v[52:55], v[196:199], v[140:143], v[52:55]
    v_permlane16_swap_b32 v152, v154
    v_permlane16_swap_b32 v153, v155
    buffer_store_dwordx4 v[152:155], v2, s[56:59], s20 offen offset:0 sc1
    v_pk_mul_f32 v[120:121], v[36:37], v[36:37]
    v_pk_mul_f32 v[122:123], v[38:39], v[38:39]
    v_pk_mul_f32 v[124:125], v[40:41], v[40:41]
    v_pk_mul_f32 v[126:127], v[42:43], v[42:43]
    v_mfma_f32_16x16x32_bf16 v[80:83], v[196:199], v[144:147], v[80:83]
    v_pk_fma_f32 v[120:121], v[120:121], v[218:219], v[216:217]
    v_pk_fma_f32 v[122:123], v[122:123], v[218:219], v[216:217]
    v_pk_fma_f32 v[124:125], v[124:125], v[218:219], v[216:217]
    v_pk_fma_f32 v[126:127], v[126:127], v[218:219], v[216:217]
    v_mfma_f32_16x16x32_bf16 v[108:111], v[196:199], v[148:151], v[108:111]
    v_pk_mul_f32 v[120:121], v[120:121], v[36:37]
    v_pk_mul_f32 v[122:123], v[122:123], v[38:39]
    v_pk_mul_f32 v[124:125], v[124:125], v[40:41]
    v_pk_mul_f32 v[126:127], v[126:127], v[42:43]
    v_mfma_f32_16x16x32_bf16 v[28:31], v[200:203], v[136:139], v[28:31]
    v_exp_f32 v120, v120
    v_exp_f32 v121, v121
    v_exp_f32 v122, v122
    v_exp_f32 v123, v123
    v_mfma_f32_16x16x32_bf16 v[56:59], v[200:203], v[140:143], v[56:59]
    v_exp_f32 v124, v124
    v_exp_f32 v125, v125
    v_exp_f32 v126, v126
    v_exp_f32 v127, v127
    v_mfma_f32_16x16x32_bf16 v[84:87], v[200:203], v[144:147], v[84:87]
    v_pk_add_f32 v[120:121], v[120:121], v[220:221]
    v_pk_add_f32 v[122:123], v[122:123], v[220:221]
    v_pk_add_f32 v[124:125], v[124:125], v[220:221]
    v_pk_add_f32 v[126:127], v[126:127], v[220:221]
    v_mfma_f32_16x16x32_bf16 v[112:115], v[200:203], v[148:151], v[112:115]
    v_rcp_f32 v120, v120
    v_rcp_f32 v121, v121
    v_rcp_f32 v122, v122
    v_rcp_f32 v123, v123
    v_mfma_f32_16x16x32_bf16 v[32:35], v[204:207], v[136:139], v[32:35]
    v_rcp_f32 v124, v124
    v_rcp_f32 v125, v125
    v_rcp_f32 v126, v126
    v_rcp_f32 v127, v127
    v_mfma_f32_16x16x32_bf16 v[60:63], v[204:207], v[140:143], v[60:63]
    v_pk_mul_f32 v[36:37], v[120:121], v[36:37]
    v_pk_mul_f32 v[38:39], v[122:123], v[38:39]
    v_pk_mul_f32 v[40:41], v[124:125], v[40:41]
    v_pk_mul_f32 v[42:43], v[126:127], v[42:43]
    v_mfma_f32_16x16x32_bf16 v[88:91], v[204:207], v[144:147], v[88:91]
    v_cvt_pk_bf16_f32 v156, v36, v37
    v_cvt_pk_bf16_f32 v157, v38, v39
    v_cvt_pk_bf16_f32 v158, v40, v41
    v_cvt_pk_bf16_f32 v159, v42, v43
    v_mfma_f32_16x16x32_bf16 v[116:119], v[204:207], v[148:151], v[116:119]
    v_permlane16_swap_b32 v156, v158
    v_permlane16_swap_b32 v157, v159
    buffer_store_dwordx4 v[156:159], v2, s[56:59], s21 offen offset:0 sc1
    v_pk_mul_f32 v[120:121], v[64:65], v[64:65]
    v_pk_mul_f32 v[122:123], v[66:67], v[66:67]
    v_pk_mul_f32 v[124:125], v[68:69], v[68:69]
    v_pk_mul_f32 v[126:127], v[70:71], v[70:71]
    v_pk_fma_f32 v[120:121], v[120:121], v[218:219], v[216:217]
    v_pk_fma_f32 v[122:123], v[122:123], v[218:219], v[216:217]
    v_pk_fma_f32 v[124:125], v[124:125], v[218:219], v[216:217]
    v_pk_fma_f32 v[126:127], v[126:127], v[218:219], v[216:217]
    v_pk_mul_f32 v[120:121], v[120:121], v[64:65]
    v_pk_mul_f32 v[122:123], v[122:123], v[66:67]
    v_pk_mul_f32 v[124:125], v[124:125], v[68:69]
    v_pk_mul_f32 v[126:127], v[126:127], v[70:71]
    v_exp_f32 v120, v120
    v_exp_f32 v121, v121
    v_exp_f32 v122, v122
    v_exp_f32 v123, v123
    v_exp_f32 v124, v124
    v_exp_f32 v125, v125
    v_exp_f32 v126, v126
    v_exp_f32 v127, v127
    v_pk_add_f32 v[120:121], v[120:121], v[220:221]
    v_pk_add_f32 v[122:123], v[122:123], v[220:221]
    v_pk_add_f32 v[124:125], v[124:125], v[220:221]
    v_pk_add_f32 v[126:127], v[126:127], v[220:221]
    v_rcp_f32 v120, v120
    v_rcp_f32 v121, v121
    v_rcp_f32 v122, v122
    v_rcp_f32 v123, v123
    v_rcp_f32 v124, v124
    v_rcp_f32 v125, v125
    v_rcp_f32 v126, v126
    v_rcp_f32 v127, v127
    v_pk_mul_f32 v[64:65], v[120:121], v[64:65]
    v_pk_mul_f32 v[66:67], v[122:123], v[66:67]
    v_pk_mul_f32 v[68:69], v[124:125], v[68:69]
    v_pk_mul_f32 v[70:71], v[126:127], v[70:71]
    v_cvt_pk_bf16_f32 v160, v64, v65
    v_cvt_pk_bf16_f32 v161, v66, v67
    v_cvt_pk_bf16_f32 v162, v68, v69
    v_cvt_pk_bf16_f32 v163, v70, v71
    s_nop 0
    v_permlane16_swap_b32 v160, v162
    v_permlane16_swap_b32 v161, v163
    buffer_store_dwordx4 v[160:163], v2, s[56:59], s22 offen offset:0 sc1
    v_pk_mul_f32 v[120:121], v[92:93], v[92:93]
    v_pk_mul_f32 v[122:123], v[94:95], v[94:95]
    v_pk_mul_f32 v[124:125], v[96:97], v[96:97]
    v_pk_mul_f32 v[126:127], v[98:99], v[98:99]
    v_pk_fma_f32 v[120:121], v[120:121], v[218:219], v[216:217]
    v_pk_fma_f32 v[122:123], v[122:123], v[218:219], v[216:217]
    v_pk_fma_f32 v[124:125], v[124:125], v[218:219], v[216:217]
    v_pk_fma_f32 v[126:127], v[126:127], v[218:219], v[216:217]
    v_pk_mul_f32 v[120:121], v[120:121], v[92:93]
    v_pk_mul_f32 v[122:123], v[122:123], v[94:95]
    v_pk_mul_f32 v[124:125], v[124:125], v[96:97]
    v_pk_mul_f32 v[126:127], v[126:127], v[98:99]
    v_exp_f32 v120, v120
    v_exp_f32 v121, v121
    v_exp_f32 v122, v122
    v_exp_f32 v123, v123
    v_exp_f32 v124, v124
    v_exp_f32 v125, v125
    v_exp_f32 v126, v126
    v_exp_f32 v127, v127
    v_pk_add_f32 v[120:121], v[120:121], v[220:221]
    v_pk_add_f32 v[122:123], v[122:123], v[220:221]
    v_pk_add_f32 v[124:125], v[124:125], v[220:221]
    v_pk_add_f32 v[126:127], v[126:127], v[220:221]
    v_rcp_f32 v120, v120
    v_rcp_f32 v121, v121
    v_rcp_f32 v122, v122
    v_rcp_f32 v123, v123
    v_rcp_f32 v124, v124
    v_rcp_f32 v125, v125
    v_rcp_f32 v126, v126
    v_rcp_f32 v127, v127
    v_pk_mul_f32 v[92:93], v[120:121], v[92:93]
    v_pk_mul_f32 v[94:95], v[122:123], v[94:95]
    v_pk_mul_f32 v[96:97], v[124:125], v[96:97]
    v_pk_mul_f32 v[98:99], v[126:127], v[98:99]
    v_cvt_pk_bf16_f32 v164, v92, v93
    v_cvt_pk_bf16_f32 v165, v94, v95
    v_cvt_pk_bf16_f32 v166, v96, v97
    v_cvt_pk_bf16_f32 v167, v98, v99
    s_nop 0
    v_permlane16_swap_b32 v164, v166
    v_permlane16_swap_b32 v165, v167
    buffer_store_dwordx4 v[164:167], v2, s[56:59], s23 offen offset:0 sc1
    v_pk_mul_f32 v[120:121], v[16:17], v[16:17]
    v_pk_mul_f32 v[122:123], v[18:19], v[18:19]
    v_pk_mul_f32 v[124:125], v[20:21], v[20:21]
    v_pk_mul_f32 v[126:127], v[22:23], v[22:23]
    v_pk_fma_f32 v[120:121], v[120:121], v[218:219], v[216:217]
    v_pk_fma_f32 v[122:123], v[122:123], v[218:219], v[216:217]
    v_pk_fma_f32 v[124:125], v[124:125], v[218:219], v[216:217]
    v_pk_fma_f32 v[126:127], v[126:127], v[218:219], v[216:217]
    v_pk_mul_f32 v[120:121], v[120:121], v[16:17]
    v_pk_mul_f32 v[122:123], v[122:123], v[18:19]
    v_pk_mul_f32 v[124:125], v[124:125], v[20:21]
    v_pk_mul_f32 v[126:127], v[126:127], v[22:23]
    v_exp_f32 v120, v120
    v_exp_f32 v121, v121
    v_exp_f32 v122, v122
    v_exp_f32 v123, v123
    v_exp_f32 v124, v124
    v_exp_f32 v125, v125
    v_exp_f32 v126, v126
    v_exp_f32 v127, v127
    v_pk_add_f32 v[120:121], v[120:121], v[220:221]
    v_pk_add_f32 v[122:123], v[122:123], v[220:221]
    v_pk_add_f32 v[124:125], v[124:125], v[220:221]
    v_pk_add_f32 v[126:127], v[126:127], v[220:221]
    v_rcp_f32 v120, v120
    v_rcp_f32 v121, v121
    v_rcp_f32 v122, v122
    v_rcp_f32 v123, v123
    v_rcp_f32 v124, v124
    v_rcp_f32 v125, v125
    v_rcp_f32 v126, v126
    v_rcp_f32 v127, v127
    v_pk_mul_f32 v[16:17], v[120:121], v[16:17]
    v_pk_mul_f32 v[18:19], v[122:123], v[18:19]
    v_pk_mul_f32 v[20:21], v[124:125], v[20:21]
    v_pk_mul_f32 v[22:23], v[126:127], v[22:23]
    v_cvt_pk_bf16_f32 v168, v16, v17
    v_cvt_pk_bf16_f32 v169, v18, v19
    v_cvt_pk_bf16_f32 v170, v20, v21
    v_cvt_pk_bf16_f32 v171, v22, v23
    s_nop 0
    v_permlane16_swap_b32 v168, v170
    v_permlane16_swap_b32 v169, v171
    buffer_store_dwordx4 v[168:171], v2, s[56:59], s20 offen offset:1024 sc1
    v_pk_mul_f32 v[120:121], v[44:45], v[44:45]
    v_pk_mul_f32 v[122:123], v[46:47], v[46:47]
    v_pk_mul_f32 v[124:125], v[48:49], v[48:49]
    v_pk_mul_f32 v[126:127], v[50:51], v[50:51]
    v_pk_fma_f32 v[120:121], v[120:121], v[218:219], v[216:217]
    v_pk_fma_f32 v[122:123], v[122:123], v[218:219], v[216:217]
    v_pk_fma_f32 v[124:125], v[124:125], v[218:219], v[216:217]
    v_pk_fma_f32 v[126:127], v[126:127], v[218:219], v[216:217]
    v_pk_mul_f32 v[120:121], v[120:121], v[44:45]
    v_pk_mul_f32 v[122:123], v[122:123], v[46:47]
    v_pk_mul_f32 v[124:125], v[124:125], v[48:49]
    v_pk_mul_f32 v[126:127], v[126:127], v[50:51]
    v_exp_f32 v120, v120
    v_exp_f32 v121, v121
    v_exp_f32 v122, v122
    v_exp_f32 v123, v123
    v_exp_f32 v124, v124
    v_exp_f32 v125, v125
    v_exp_f32 v126, v126
    v_exp_f32 v127, v127
    v_pk_add_f32 v[120:121], v[120:121], v[220:221]
    v_pk_add_f32 v[122:123], v[122:123], v[220:221]
    v_pk_add_f32 v[124:125], v[124:125], v[220:221]
    v_pk_add_f32 v[126:127], v[126:127], v[220:221]
    v_rcp_f32 v120, v120
    v_rcp_f32 v121, v121
    v_rcp_f32 v122, v122
    v_rcp_f32 v123, v123
    v_rcp_f32 v124, v124
    v_rcp_f32 v125, v125
    v_rcp_f32 v126, v126
    v_rcp_f32 v127, v127
    v_pk_mul_f32 v[44:45], v[120:121], v[44:45]
    v_pk_mul_f32 v[46:47], v[122:123], v[46:47]
    v_pk_mul_f32 v[48:49], v[124:125], v[48:49]
    v_pk_mul_f32 v[50:51], v[126:127], v[50:51]
    v_cvt_pk_bf16_f32 v172, v44, v45
    v_cvt_pk_bf16_f32 v173, v46, v47
    v_cvt_pk_bf16_f32 v174, v48, v49
    v_cvt_pk_bf16_f32 v175, v50, v51
    s_nop 0
    v_permlane16_swap_b32 v172, v174
    v_permlane16_swap_b32 v173, v175
    buffer_store_dwordx4 v[172:175], v2, s[56:59], s21 offen offset:1024 sc1
    v_pk_mul_f32 v[120:121], v[72:73], v[72:73]
    v_pk_mul_f32 v[122:123], v[74:75], v[74:75]
    v_pk_mul_f32 v[124:125], v[76:77], v[76:77]
    v_pk_mul_f32 v[126:127], v[78:79], v[78:79]
    v_pk_fma_f32 v[120:121], v[120:121], v[218:219], v[216:217]
    v_pk_fma_f32 v[122:123], v[122:123], v[218:219], v[216:217]
    v_pk_fma_f32 v[124:125], v[124:125], v[218:219], v[216:217]
    v_pk_fma_f32 v[126:127], v[126:127], v[218:219], v[216:217]
    v_pk_mul_f32 v[120:121], v[120:121], v[72:73]
    v_pk_mul_f32 v[122:123], v[122:123], v[74:75]
    v_pk_mul_f32 v[124:125], v[124:125], v[76:77]
    v_pk_mul_f32 v[126:127], v[126:127], v[78:79]
    v_exp_f32 v120, v120
    v_exp_f32 v121, v121
    v_exp_f32 v122, v122
    v_exp_f32 v123, v123
    v_exp_f32 v124, v124
    v_exp_f32 v125, v125
    v_exp_f32 v126, v126
    v_exp_f32 v127, v127
    v_pk_add_f32 v[120:121], v[120:121], v[220:221]
    v_pk_add_f32 v[122:123], v[122:123], v[220:221]
    v_pk_add_f32 v[124:125], v[124:125], v[220:221]
    v_pk_add_f32 v[126:127], v[126:127], v[220:221]
    v_rcp_f32 v120, v120
    v_rcp_f32 v121, v121
    v_rcp_f32 v122, v122
    v_rcp_f32 v123, v123
    v_rcp_f32 v124, v124
    v_rcp_f32 v125, v125
    v_rcp_f32 v126, v126
    v_rcp_f32 v127, v127
    v_pk_mul_f32 v[72:73], v[120:121], v[72:73]
    v_pk_mul_f32 v[74:75], v[122:123], v[74:75]
    v_pk_mul_f32 v[76:77], v[124:125], v[76:77]
    v_pk_mul_f32 v[78:79], v[126:127], v[78:79]
    v_cvt_pk_bf16_f32 v176, v72, v73
    v_cvt_pk_bf16_f32 v177, v74, v75
    v_cvt_pk_bf16_f32 v178, v76, v77
    v_cvt_pk_bf16_f32 v179, v78, v79
    s_nop 0
    v_permlane16_swap_b32 v176, v178
    v_permlane16_swap_b32 v177, v179
    buffer_store_dwordx4 v[176:179], v2, s[56:59], s22 offen offset:1024 sc1
    v_pk_mul_f32 v[120:121], v[100:101], v[100:101]
    v_pk_mul_f32 v[122:123], v[102:103], v[102:103]
    v_pk_mul_f32 v[124:125], v[104:105], v[104:105]
    v_pk_mul_f32 v[126:127], v[106:107], v[106:107]
    v_pk_fma_f32 v[120:121], v[120:121], v[218:219], v[216:217]
    v_pk_fma_f32 v[122:123], v[122:123], v[218:219], v[216:217]
    v_pk_fma_f32 v[124:125], v[124:125], v[218:219], v[216:217]
    v_pk_fma_f32 v[126:127], v[126:127], v[218:219], v[216:217]
    v_pk_mul_f32 v[120:121], v[120:121], v[100:101]
    v_pk_mul_f32 v[122:123], v[122:123], v[102:103]
    v_pk_mul_f32 v[124:125], v[124:125], v[104:105]
    v_pk_mul_f32 v[126:127], v[126:127], v[106:107]
    v_exp_f32 v120, v120
    v_exp_f32 v121, v121
    v_exp_f32 v122, v122
    v_exp_f32 v123, v123
    v_exp_f32 v124, v124
    v_exp_f32 v125, v125
    v_exp_f32 v126, v126
    v_exp_f32 v127, v127
    v_pk_add_f32 v[120:121], v[120:121], v[220:221]
    v_pk_add_f32 v[122:123], v[122:123], v[220:221]
    v_pk_add_f32 v[124:125], v[124:125], v[220:221]
    v_pk_add_f32 v[126:127], v[126:127], v[220:221]
    v_rcp_f32 v120, v120
    v_rcp_f32 v121, v121
    v_rcp_f32 v122, v122
    v_rcp_f32 v123, v123
    v_rcp_f32 v124, v124
    v_rcp_f32 v125, v125
    v_rcp_f32 v126, v126
    v_rcp_f32 v127, v127
    v_pk_mul_f32 v[100:101], v[120:121], v[100:101]
    v_pk_mul_f32 v[102:103], v[122:123], v[102:103]
    v_pk_mul_f32 v[104:105], v[124:125], v[104:105]
    v_pk_mul_f32 v[106:107], v[126:127], v[106:107]
    v_cvt_pk_bf16_f32 v152, v100, v101
    v_cvt_pk_bf16_f32 v153, v102, v103
    v_cvt_pk_bf16_f32 v154, v104, v105
    v_cvt_pk_bf16_f32 v155, v106, v107
    s_nop 0
    v_permlane16_swap_b32 v152, v154
    v_permlane16_swap_b32 v153, v155
    buffer_store_dwordx4 v[152:155], v2, s[56:59], s23 offen offset:1024 sc1
    v_pk_mul_f32 v[120:121], v[24:25], v[24:25]
    v_pk_mul_f32 v[122:123], v[26:27], v[26:27]
    v_pk_mul_f32 v[124:125], v[28:29], v[28:29]
    v_pk_mul_f32 v[126:127], v[30:31], v[30:31]
    v_pk_fma_f32 v[120:121], v[120:121], v[218:219], v[216:217]
    v_pk_fma_f32 v[122:123], v[122:123], v[218:219], v[216:217]
    v_pk_fma_f32 v[124:125], v[124:125], v[218:219], v[216:217]
    v_pk_fma_f32 v[126:127], v[126:127], v[218:219], v[216:217]
    v_pk_mul_f32 v[120:121], v[120:121], v[24:25]
    v_pk_mul_f32 v[122:123], v[122:123], v[26:27]
    v_pk_mul_f32 v[124:125], v[124:125], v[28:29]
    v_pk_mul_f32 v[126:127], v[126:127], v[30:31]
    v_exp_f32 v120, v120
    v_exp_f32 v121, v121
    v_exp_f32 v122, v122
    v_exp_f32 v123, v123
    v_exp_f32 v124, v124
    v_exp_f32 v125, v125
    v_exp_f32 v126, v126
    v_exp_f32 v127, v127
    v_pk_add_f32 v[120:121], v[120:121], v[220:221]
    v_pk_add_f32 v[122:123], v[122:123], v[220:221]
    v_pk_add_f32 v[124:125], v[124:125], v[220:221]
    v_pk_add_f32 v[126:127], v[126:127], v[220:221]
    v_rcp_f32 v120, v120
    v_rcp_f32 v121, v121
    v_rcp_f32 v122, v122
    v_rcp_f32 v123, v123
    v_rcp_f32 v124, v124
    v_rcp_f32 v125, v125
    v_rcp_f32 v126, v126
    v_rcp_f32 v127, v127
    v_pk_mul_f32 v[24:25], v[120:121], v[24:25]
    v_pk_mul_f32 v[26:27], v[122:123], v[26:27]
    v_pk_mul_f32 v[28:29], v[124:125], v[28:29]
    v_pk_mul_f32 v[30:31], v[126:127], v[30:31]
    v_cvt_pk_bf16_f32 v156, v24, v25
    v_cvt_pk_bf16_f32 v157, v26, v27
    v_cvt_pk_bf16_f32 v158, v28, v29
    v_cvt_pk_bf16_f32 v159, v30, v31
    s_nop 0
    v_permlane16_swap_b32 v156, v158
    v_permlane16_swap_b32 v157, v159
    buffer_store_dwordx4 v[156:159], v2, s[56:59], s20 offen offset:2048 sc1
    v_pk_mul_f32 v[120:121], v[52:53], v[52:53]
    v_pk_mul_f32 v[122:123], v[54:55], v[54:55]
    v_pk_mul_f32 v[124:125], v[56:57], v[56:57]
    v_pk_mul_f32 v[126:127], v[58:59], v[58:59]
    v_pk_fma_f32 v[120:121], v[120:121], v[218:219], v[216:217]
    v_pk_fma_f32 v[122:123], v[122:123], v[218:219], v[216:217]
    v_pk_fma_f32 v[124:125], v[124:125], v[218:219], v[216:217]
    v_pk_fma_f32 v[126:127], v[126:127], v[218:219], v[216:217]
    v_pk_mul_f32 v[120:121], v[120:121], v[52:53]
    v_pk_mul_f32 v[122:123], v[122:123], v[54:55]
    v_pk_mul_f32 v[124:125], v[124:125], v[56:57]
    v_pk_mul_f32 v[126:127], v[126:127], v[58:59]
    v_exp_f32 v120, v120
    v_exp_f32 v121, v121
    v_exp_f32 v122, v122
    v_exp_f32 v123, v123
    v_exp_f32 v124, v124
    v_exp_f32 v125, v125
    v_exp_f32 v126, v126
    v_exp_f32 v127, v127
    v_pk_add_f32 v[120:121], v[120:121], v[220:221]
    v_pk_add_f32 v[122:123], v[122:123], v[220:221]
    v_pk_add_f32 v[124:125], v[124:125], v[220:221]
    v_pk_add_f32 v[126:127], v[126:127], v[220:221]
    v_rcp_f32 v120, v120
    v_rcp_f32 v121, v121
    v_rcp_f32 v122, v122
    v_rcp_f32 v123, v123
    v_rcp_f32 v124, v124
    v_rcp_f32 v125, v125
    v_rcp_f32 v126, v126
    v_rcp_f32 v127, v127
    v_pk_mul_f32 v[52:53], v[120:121], v[52:53]
    v_pk_mul_f32 v[54:55], v[122:123], v[54:55]
    v_pk_mul_f32 v[56:57], v[124:125], v[56:57]
    v_pk_mul_f32 v[58:59], v[126:127], v[58:59]
    v_cvt_pk_bf16_f32 v160, v52, v53
    v_cvt_pk_bf16_f32 v161, v54, v55
    v_cvt_pk_bf16_f32 v162, v56, v57
    v_cvt_pk_bf16_f32 v163, v58, v59
    s_nop 0
    v_permlane16_swap_b32 v160, v162
    v_permlane16_swap_b32 v161, v163
    buffer_store_dwordx4 v[160:163], v2, s[56:59], s21 offen offset:2048 sc1
    v_pk_mul_f32 v[120:121], v[80:81], v[80:81]
    v_pk_mul_f32 v[122:123], v[82:83], v[82:83]
    v_pk_mul_f32 v[124:125], v[84:85], v[84:85]
    v_pk_mul_f32 v[126:127], v[86:87], v[86:87]
    v_pk_fma_f32 v[120:121], v[120:121], v[218:219], v[216:217]
    v_pk_fma_f32 v[122:123], v[122:123], v[218:219], v[216:217]
    v_pk_fma_f32 v[124:125], v[124:125], v[218:219], v[216:217]
    v_pk_fma_f32 v[126:127], v[126:127], v[218:219], v[216:217]
    v_pk_mul_f32 v[120:121], v[120:121], v[80:81]
    v_pk_mul_f32 v[122:123], v[122:123], v[82:83]
    v_pk_mul_f32 v[124:125], v[124:125], v[84:85]
    v_pk_mul_f32 v[126:127], v[126:127], v[86:87]
    v_exp_f32 v120, v120
    v_exp_f32 v121, v121
    v_exp_f32 v122, v122
    v_exp_f32 v123, v123
    v_exp_f32 v124, v124
    v_exp_f32 v125, v125
    v_exp_f32 v126, v126
    v_exp_f32 v127, v127
    v_pk_add_f32 v[120:121], v[120:121], v[220:221]
    v_pk_add_f32 v[122:123], v[122:123], v[220:221]
    v_pk_add_f32 v[124:125], v[124:125], v[220:221]
    v_pk_add_f32 v[126:127], v[126:127], v[220:221]
    v_rcp_f32 v120, v120
    v_rcp_f32 v121, v121
    v_rcp_f32 v122, v122
    v_rcp_f32 v123, v123
    v_rcp_f32 v124, v124
    v_rcp_f32 v125, v125
    v_rcp_f32 v126, v126
    v_rcp_f32 v127, v127
    v_pk_mul_f32 v[80:81], v[120:121], v[80:81]
    v_pk_mul_f32 v[82:83], v[122:123], v[82:83]
    v_pk_mul_f32 v[84:85], v[124:125], v[84:85]
    v_pk_mul_f32 v[86:87], v[126:127], v[86:87]
    v_cvt_pk_bf16_f32 v164, v80, v81
    v_cvt_pk_bf16_f32 v165, v82, v83
    v_cvt_pk_bf16_f32 v166, v84, v85
    v_cvt_pk_bf16_f32 v167, v86, v87
    s_nop 0
    v_permlane16_swap_b32 v164, v166
    v_permlane16_swap_b32 v165, v167
    buffer_store_dwordx4 v[164:167], v2, s[56:59], s22 offen offset:2048 sc1
    v_pk_mul_f32 v[120:121], v[108:109], v[108:109]
    v_pk_mul_f32 v[122:123], v[110:111], v[110:111]
    v_pk_mul_f32 v[124:125], v[112:113], v[112:113]
    v_pk_mul_f32 v[126:127], v[114:115], v[114:115]
    v_pk_fma_f32 v[120:121], v[120:121], v[218:219], v[216:217]
    v_pk_fma_f32 v[122:123], v[122:123], v[218:219], v[216:217]
    v_pk_fma_f32 v[124:125], v[124:125], v[218:219], v[216:217]
    v_pk_fma_f32 v[126:127], v[126:127], v[218:219], v[216:217]
    v_pk_mul_f32 v[120:121], v[120:121], v[108:109]
    v_pk_mul_f32 v[122:123], v[122:123], v[110:111]
    v_pk_mul_f32 v[124:125], v[124:125], v[112:113]
    v_pk_mul_f32 v[126:127], v[126:127], v[114:115]
    v_exp_f32 v120, v120
    v_exp_f32 v121, v121
    v_exp_f32 v122, v122
    v_exp_f32 v123, v123
    v_exp_f32 v124, v124
    v_exp_f32 v125, v125
    v_exp_f32 v126, v126
    v_exp_f32 v127, v127
    v_pk_add_f32 v[120:121], v[120:121], v[220:221]
    v_pk_add_f32 v[122:123], v[122:123], v[220:221]
    v_pk_add_f32 v[124:125], v[124:125], v[220:221]
    v_pk_add_f32 v[126:127], v[126:127], v[220:221]
    v_rcp_f32 v120, v120
    v_rcp_f32 v121, v121
    v_rcp_f32 v122, v122
    v_rcp_f32 v123, v123
    v_rcp_f32 v124, v124
    v_rcp_f32 v125, v125
    v_rcp_f32 v126, v126
    v_rcp_f32 v127, v127
    v_pk_mul_f32 v[108:109], v[120:121], v[108:109]
    v_pk_mul_f32 v[110:111], v[122:123], v[110:111]
    v_pk_mul_f32 v[112:113], v[124:125], v[112:113]
    v_pk_mul_f32 v[114:115], v[126:127], v[114:115]
    v_cvt_pk_bf16_f32 v168, v108, v109
    v_cvt_pk_bf16_f32 v169, v110, v111
    v_cvt_pk_bf16_f32 v170, v112, v113
    v_cvt_pk_bf16_f32 v171, v114, v115
    s_nop 0
    v_permlane16_swap_b32 v168, v170
    v_permlane16_swap_b32 v169, v171
    buffer_store_dwordx4 v[168:171], v2, s[56:59], s23 offen offset:2048 sc1
    v_pk_mul_f32 v[120:121], v[32:33], v[32:33]
    v_pk_mul_f32 v[122:123], v[34:35], v[34:35]
    v_pk_fma_f32 v[120:121], v[120:121], v[218:219], v[216:217]
    v_pk_fma_f32 v[122:123], v[122:123], v[218:219], v[216:217]
    v_pk_mul_f32 v[120:121], v[120:121], v[32:33]
    v_pk_mul_f32 v[122:123], v[122:123], v[34:35]
    v_exp_f32 v120, v120
    v_exp_f32 v121, v121
    v_exp_f32 v122, v122
    v_exp_f32 v123, v123
    v_pk_add_f32 v[120:121], v[120:121], v[220:221]
    v_pk_add_f32 v[122:123], v[122:123], v[220:221]
    v_rcp_f32 v120, v120
    v_rcp_f32 v121, v121
    v_rcp_f32 v122, v122
    v_rcp_f32 v123, v123
    v_pk_mul_f32 v[32:33], v[120:121], v[32:33]
    v_pk_mul_f32 v[34:35], v[122:123], v[34:35]
    v_cvt_pk_bf16_f32 v172, v32, v33
    v_cvt_pk_bf16_f32 v173, v34, v35
    buffer_store_dwordx2 v[172:173], v3, s[56:59], s20 offen sc1
    v_pk_mul_f32 v[120:121], v[60:61], v[60:61]
    v_pk_mul_f32 v[122:123], v[62:63], v[62:63]
    v_pk_fma_f32 v[120:121], v[120:121], v[218:219], v[216:217]
    v_pk_fma_f32 v[122:123], v[122:123], v[218:219], v[216:217]
    v_pk_mul_f32 v[120:121], v[120:121], v[60:61]
    v_pk_mul_f32 v[122:123], v[122:123], v[62:63]
    v_exp_f32 v120, v120
    v_exp_f32 v121, v121
    v_exp_f32 v122, v122
    v_exp_f32 v123, v123
    v_pk_add_f32 v[120:121], v[120:121], v[220:221]
    v_pk_add_f32 v[122:123], v[122:123], v[220:221]
    v_rcp_f32 v120, v120
    v_rcp_f32 v121, v121
    v_rcp_f32 v122, v122
    v_rcp_f32 v123, v123
    v_pk_mul_f32 v[60:61], v[120:121], v[60:61]
    v_pk_mul_f32 v[62:63], v[122:123], v[62:63]
    v_cvt_pk_bf16_f32 v176, v60, v61
    v_cvt_pk_bf16_f32 v177, v62, v63
    buffer_store_dwordx2 v[176:177], v3, s[56:59], s21 offen sc1
    v_pk_mul_f32 v[120:121], v[88:89], v[88:89]
    v_pk_mul_f32 v[122:123], v[90:91], v[90:91]
    v_pk_fma_f32 v[120:121], v[120:121], v[218:219], v[216:217]
    v_pk_fma_f32 v[122:123], v[122:123], v[218:219], v[216:217]
    v_pk_mul_f32 v[120:121], v[120:121], v[88:89]
    v_pk_mul_f32 v[122:123], v[122:123], v[90:91]
    v_exp_f32 v120, v120
    v_exp_f32 v121, v121
    v_exp_f32 v122, v122
    v_exp_f32 v123, v123
    v_pk_add_f32 v[120:121], v[120:121], v[220:221]
    v_pk_add_f32 v[122:123], v[122:123], v[220:221]
    v_rcp_f32 v120, v120
    v_rcp_f32 v121, v121
    v_rcp_f32 v122, v122
    v_rcp_f32 v123, v123
    v_pk_mul_f32 v[88:89], v[120:121], v[88:89]
    v_pk_mul_f32 v[90:91], v[122:123], v[90:91]
    v_cvt_pk_bf16_f32 v152, v88, v89
    v_cvt_pk_bf16_f32 v153, v90, v91
    buffer_store_dwordx2 v[152:153], v3, s[56:59], s22 offen sc1
    v_pk_mul_f32 v[120:121], v[116:117], v[116:117]
    v_pk_mul_f32 v[122:123], v[118:119], v[118:119]
    v_pk_fma_f32 v[120:121], v[120:121], v[218:219], v[216:217]
    v_pk_fma_f32 v[122:123], v[122:123], v[218:219], v[216:217]
    v_pk_mul_f32 v[120:121], v[120:121], v[116:117]
    v_pk_mul_f32 v[122:123], v[122:123], v[118:119]
    v_exp_f32 v120, v120
    v_exp_f32 v121, v121
    v_exp_f32 v122, v122
    v_exp_f32 v123, v123
    v_pk_add_f32 v[120:121], v[120:121], v[220:221]
    v_pk_add_f32 v[122:123], v[122:123], v[220:221]
    v_rcp_f32 v120, v120
    v_rcp_f32 v121, v121
    v_rcp_f32 v122, v122
    v_rcp_f32 v123, v123
    v_pk_mul_f32 v[116:117], v[120:121], v[116:117]
    v_pk_mul_f32 v[118:119], v[122:123], v[118:119]
    v_cvt_pk_bf16_f32 v156, v116, v117
    v_cvt_pk_bf16_f32 v157, v118, v119
    buffer_store_dwordx2 v[156:157], v3, s[56:59], s23 offen sc1
LnoCP_13:
    s_waitcnt vmcnt(0)
    v_mov_b32 v250, 151556
    v_mov_b32 v251, 1
    s_mov_b64 exec, 1
    ds_add_rtn_u32 v251, v250, v251
    s_waitcnt lgkmcnt(0)
    v_readfirstlane_b32 s7, v251
    s_nop 0
    s_cmp_eq_u32 s7, 3
    s_cbranch_scc0 Lsg_15
    v_mov_b32 v250, 0
    v_mov_b32 v251, 1
    buffer_store_dword v251, v250, s[56:59], s100 offen sc1
Lsg_15:
    s_mov_b64 exec, -1
Lcpd_14:
    s_and_b32 s78, s83, 7
    s_lshl_b32 s30, s78, 7
    s_lshr_b32 s78, s83, 3
    s_mul_i32 s31, s78, 1792

    s_and_b32 s70, s28, 1
    s_mul_i32 s70, s70, 8192
    v_and_b32 v144, 15, v1
    v_lshlrev_b32 v136, 7, v144
    v_lshrrev_b32 v144, 1, v144
    v_lshrrev_b32 v145, 4, v1
    v_xor_b32 v144, v144, v145
    v_lshlrev_b32 v144, 4, v144
    v_add3_u32 v136, v136, v144, s70
    v_xor_b32 v137, 64, v136
    s_lshr_b32 s70, s28, 1
    s_mul_i32 s71, s70, 4
    v_lshrrev_b32 v144, 4, v1
    v_lshlrev_b32 v144, 3, v144
    v_bfe_u32 v145, v1, 2, 2
    v_add_u32 v144, v144, v145
    v_and_b32 v145, 3, v144
    v_lshlrev_b32 v145, 1, v145
    v_and_b32 v138, 8, v144
    v_or_b32 v145, v145, v138
    s_add_u32 s72, s71, 0
    s_lshl_b32 s72, s72, 1
    v_xor_b32 v145, s72, v145
    v_bfe_u32 v138, v1, 1, 1
    v_or_b32 v145, v145, v138
    v_lshlrev_b32 v145, 4, v145
    v_mul_u32_u24 v138, 256, v144
    v_add_u32 v138, v138, v145
    v_and_b32 v145, 1, v1
    v_lshlrev_b32 v145, 3, v145
    v_add_u32 v138, v138, v145
    v_add_u32 v138, 16384, v138
    v_and_b32 v145, 3, v144
    v_lshlrev_b32 v145, 1, v145
    v_and_b32 v139, 8, v144
    v_or_b32 v145, v145, v139
    s_add_u32 s72, s71, 1
    s_lshl_b32 s72, s72, 1
    v_xor_b32 v145, s72, v145
    v_bfe_u32 v139, v1, 1, 1
    v_or_b32 v145, v145, v139
    v_lshlrev_b32 v145, 4, v145
    v_mul_u32_u24 v139, 256, v144
    v_add_u32 v139, v139, v145
    v_and_b32 v145, 1, v1
    v_lshlrev_b32 v145, 3, v145
    v_add_u32 v139, v139, v145
    v_add_u32 v139, 16384, v139
    v_and_b32 v145, 3, v144
    v_lshlrev_b32 v145, 1, v145
    v_and_b32 v140, 8, v144
    v_or_b32 v145, v145, v140
    s_add_u32 s72, s71, 2
    s_lshl_b32 s72, s72, 1
    v_xor_b32 v145, s72, v145
    v_bfe_u32 v140, v1, 1, 1
    v_or_b32 v145, v145, v140
    v_lshlrev_b32 v145, 4, v145
    v_mul_u32_u24 v140, 256, v144
    v_add_u32 v140, v140, v145
    v_and_b32 v145, 1, v1
    v_lshlrev_b32 v145, 3, v145
    v_add_u32 v140, v140, v145
    v_add_u32 v140, 16384, v140
    v_and_b32 v145, 3, v144
    v_lshlrev_b32 v145, 1, v145
    v_and_b32 v141, 8, v144
    v_or_b32 v145, v145, v141
    s_add_u32 s72, s71, 3
    s_lshl_b32 s72, s72, 1
    v_xor_b32 v145, s72, v145
    v_bfe_u32 v141, v1, 1, 1
    v_or_b32 v145, v145, v141
    v_lshlrev_b32 v145, 4, v145
    v_mul_u32_u24 v141, 256, v144
    v_add_u32 v141, v141, v145
    v_and_b32 v145, 1, v1
    v_lshlrev_b32 v145, 3, v145
    v_add_u32 v141, v141, v145
    v_add_u32 v141, 16384, v141
    s_mov_b32 s18, 0
    v_mov_b32 v8, 0
    v_mov_b32 v9, 0
    v_mov_b32 v10, 0
    v_mov_b32 v11, 0
    v_mov_b32 v12, 0
    v_mov_b32 v13, 0
    v_mov_b32 v14, 0
    v_mov_b32 v15, 0
    v_mov_b32 v16, 0
    v_mov_b32 v17, 0
    v_mov_b32 v18, 0
    v_mov_b32 v19, 0
    v_mov_b32 v20, 0
    v_mov_b32 v21, 0
    v_mov_b32 v22, 0
    v_mov_b32 v23, 0
    v_mov_b32 v24, 0
    v_mov_b32 v25, 0
    v_mov_b32 v26, 0
    v_mov_b32 v27, 0
    v_mov_b32 v28, 0
    v_mov_b32 v29, 0
    v_mov_b32 v30, 0
    v_mov_b32 v31, 0
    v_mov_b32 v32, 0
    v_mov_b32 v33, 0
    v_mov_b32 v34, 0
    v_mov_b32 v35, 0
    v_mov_b32 v36, 0
    v_mov_b32 v37, 0
    v_mov_b32 v38, 0
    v_mov_b32 v39, 0
    v_mov_b32 v40, 0
    v_mov_b32 v41, 0
    v_mov_b32 v42, 0
    v_mov_b32 v43, 0
    v_mov_b32 v44, 0
    v_mov_b32 v45, 0
    v_mov_b32 v46, 0
    v_mov_b32 v47, 0
    v_mov_b32 v48, 0
    v_mov_b32 v49, 0
    v_mov_b32 v50, 0
    v_mov_b32 v51, 0
    v_mov_b32 v52, 0
    v_mov_b32 v53, 0
    v_mov_b32 v54, 0
    v_mov_b32 v55, 0
    v_mov_b32 v56, 0
    v_mov_b32 v57, 0
    v_mov_b32 v58, 0
    v_mov_b32 v59, 0
    v_mov_b32 v60, 0
    v_mov_b32 v61, 0
    v_mov_b32 v62, 0
    v_mov_b32 v63, 0
    v_mov_b32 v64, 0
    v_mov_b32 v65, 0
    v_mov_b32 v66, 0
    v_mov_b32 v67, 0
    v_mov_b32 v68, 0
    v_mov_b32 v69, 0
    v_mov_b32 v70, 0
    v_mov_b32 v71, 0
    s_waitcnt vmcnt(0)
    s_lshl_b32 s4, s2, 2
    s_add_u32 s4, s4, s28
    s_lshl_b32 s4, s4, 12
    s_add_u32 s4, s4, 33554432
    s_xor_b32 s5, s4, 65536
    s_xor_b32 s6, s101, 512
    v_lshlrev_b32 v2, 4, v1
    s_lshr_b32 s20, s83, 3
    s_lshl_b32 s21, s20, 5
    s_and_b32 s22, s28, 1
    s_lshl_b32 s22, s22, 6
    s_add_u32 s21, s21, s22
    s_add_u32 s21, s21, s29
    v_and_b32 v3, 15, v1
    v_add_u32 v3, s21, v3

    s_lshr_b32 s22, s28, 1
    s_lshl_b32 s22, s22, 6
    s_add_u32 s22, s22, s30
    s_lshl_b32 s22, s22, 1
    v_lshlrev_b32 v4, 11, v3
    v_add_u32 v4, s22, v4
    v_lshrrev_b32 v5, 4, v1
    v_lshl_add_u32 v6, v5, 3, v4
    v_and_b32 v7, 1, v5
    v_lshlrev_b32 v7, 5, v7
    v_lshrrev_b32 v5, 1, v5
    v_lshl_add_u32 v7, v5, 4, v7
    v_add_u32 v7, v7, v4

    v_add_u32 v208, 0, v3
    v_lshrrev_b32 v209, 7, v208
    v_lshlrev_b32 v209, 13, v209
    v_bfe_u32 v210, v208, 1, 4
    v_lshl_add_u32 v209, v210, 9, v209
    v_bfe_u32 v210, v208, 5, 2
    v_lshl_add_u32 v209, v210, 7, v209
    v_and_b32 v210, 1, v208
    v_lshl_add_u32 v209, v210, 2, v209
    s_mov_b32 s23, 26214400
    buffer_load_dword v200, v209, s[56:59], s23 offen sc1
    v_add_u32 v208, 16, v3
    v_lshrrev_b32 v209, 7, v208
    v_lshlrev_b32 v209, 13, v209
    v_bfe_u32 v210, v208, 1, 4
    v_lshl_add_u32 v209, v210, 9, v209
    v_bfe_u32 v210, v208, 5, 2
    v_lshl_add_u32 v209, v210, 7, v209
    v_and_b32 v210, 1, v208
    v_lshl_add_u32 v209, v210, 2, v209
    s_mov_b32 s23, 26214400
    buffer_load_dword v201, v209, s[56:59], s23 offen sc1
    s_mov_b32 s64, s50
    s_mov_b32 s65, s51
    s_mov_b32 s66, 4194304
    s_mov_b32 s67, 0x20000
    s_mov_b32 s76, 4294836224
    s_mov_b32 s77, 32768
    s_barrier
    ds_read_b64_tr_b16 v[104:105], v138 offset:0
    ds_read_b64_tr_b16 v[106:107], v138 offset:1024
    ds_read_b128 v[72:75], v136 offset:0
    ds_read_b128 v[76:79], v136 offset:2048
    ds_read_b128 v[80:83], v136 offset:4096
    ds_read_b128 v[84:87], v136 offset:6144
    ds_read_b64_tr_b16 v[108:109], v139 offset:0
    ds_read_b64_tr_b16 v[110:111], v139 offset:1024
    ds_read_b64_tr_b16 v[112:113], v140 offset:0
    ds_read_b64_tr_b16 v[114:115], v140 offset:1024
    ds_read_b64_tr_b16 v[116:117], v141 offset:0
    ds_read_b64_tr_b16 v[118:119], v141 offset:1024
    s_waitcnt lgkmcnt(0)
    s_mov_b32 s19, 27
.p2align 6
Lcons_16:
    v_mfma_f32_16x16x32_bf16 v[8:11], v[104:107], v[72:75], v[8:11]
    ds_read_b64_tr_b16 v[120:121], v138 offset:8192
    ds_read_b64_tr_b16 v[122:123], v138 offset:9216
    v_mfma_f32_16x16x32_bf16 v[24:27], v[104:107], v[76:79], v[24:27]
    ds_read_b128 v[88:91], v137 offset:0
    ds_read_b128 v[92:95], v137 offset:2048
    v_mfma_f32_16x16x32_bf16 v[40:43], v[104:107], v[80:83], v[40:43]
    ds_read_b128 v[96:99], v137 offset:4096
    ds_read_b128 v[100:103], v137 offset:6144
    v_mfma_f32_16x16x32_bf16 v[56:59], v[104:107], v[84:87], v[56:59]
    ds_read_b64_tr_b16 v[124:125], v139 offset:8192
    ds_read_b64_tr_b16 v[126:127], v139 offset:9216
    v_mfma_f32_16x16x32_bf16 v[12:15], v[108:111], v[72:75], v[12:15]
    ds_read_b64_tr_b16 v[128:129], v140 offset:8192
    ds_read_b64_tr_b16 v[130:131], v140 offset:9216
    v_mfma_f32_16x16x32_bf16 v[28:31], v[108:111], v[76:79], v[28:31]
    ds_read_b64_tr_b16 v[132:133], v141 offset:8192
    ds_read_b64_tr_b16 v[134:135], v141 offset:9216
    v_mfma_f32_16x16x32_bf16 v[44:47], v[108:111], v[80:83], v[44:47]
    s_add_u32 s18, s18, 32768
    v_mfma_f32_16x16x32_bf16 v[60:63], v[108:111], v[84:87], v[60:63]
    s_cmp_eq_u32 s18, 163840
    v_mfma_f32_16x16x32_bf16 v[16:19], v[112:115], v[72:75], v[16:19]
    s_cselect_b32 s70, s76, s77
    v_mfma_f32_16x16x32_bf16 v[32:35], v[112:115], v[76:79], v[32:35]
    s_cselect_b32 s18, 0, s18
    v_mfma_f32_16x16x32_bf16 v[48:51], v[112:115], v[80:83], v[48:51]
    v_add_u32 v136, s70, v136
    v_mfma_f32_16x16x32_bf16 v[64:67], v[112:115], v[84:87], v[64:67]
    v_add_u32 v137, s70, v137
    v_mfma_f32_16x16x32_bf16 v[20:23], v[116:119], v[72:75], v[20:23]
    v_add_u32 v138, s70, v138
    v_mfma_f32_16x16x32_bf16 v[36:39], v[116:119], v[76:79], v[36:39]
    v_add_u32 v139, s70, v139
    v_add_u32 v140, s70, v140
    v_add_u32 v141, s70, v141
    s_waitcnt lgkmcnt(0)
    s_barrier
    v_mfma_f32_16x16x32_bf16 v[52:55], v[116:119], v[80:83], v[52:55]
    v_mfma_f32_16x16x32_bf16 v[68:71], v[116:119], v[84:87], v[68:71]
    v_mfma_f32_16x16x32_bf16 v[8:11], v[120:123], v[88:91], v[8:11]
    ds_read_b64_tr_b16 v[104:105], v138 offset:0
    ds_read_b64_tr_b16 v[106:107], v138 offset:1024
    v_mfma_f32_16x16x32_bf16 v[24:27], v[120:123], v[92:95], v[24:27]
    ds_read_b128 v[72:75], v136 offset:0
    ds_read_b128 v[76:79], v136 offset:2048
    v_mfma_f32_16x16x32_bf16 v[40:43], v[120:123], v[96:99], v[40:43]
    ds_read_b128 v[80:83], v136 offset:4096
    ds_read_b128 v[84:87], v136 offset:6144
    v_mfma_f32_16x16x32_bf16 v[56:59], v[120:123], v[100:103], v[56:59]
    ds_read_b64_tr_b16 v[108:109], v139 offset:0
    ds_read_b64_tr_b16 v[110:111], v139 offset:1024
    v_mfma_f32_16x16x32_bf16 v[12:15], v[124:127], v[88:91], v[12:15]
    ds_read_b64_tr_b16 v[112:113], v140 offset:0
    ds_read_b64_tr_b16 v[114:115], v140 offset:1024
    v_mfma_f32_16x16x32_bf16 v[28:31], v[124:127], v[92:95], v[28:31]
    ds_read_b64_tr_b16 v[116:117], v141 offset:0
    ds_read_b64_tr_b16 v[118:119], v141 offset:1024
    v_mfma_f32_16x16x32_bf16 v[44:47], v[124:127], v[96:99], v[44:47]
    s_sub_u32 s19, s19, 1
    v_mfma_f32_16x16x32_bf16 v[60:63], v[124:127], v[100:103], v[60:63]
    s_cmp_lg_u32 s19, 0
    v_mfma_f32_16x16x32_bf16 v[16:19], v[128:131], v[88:91], v[16:19]
    v_mfma_f32_16x16x32_bf16 v[32:35], v[128:131], v[92:95], v[32:35]
    v_mfma_f32_16x16x32_bf16 v[48:51], v[128:131], v[96:99], v[48:51]
    v_mfma_f32_16x16x32_bf16 v[64:67], v[128:131], v[100:103], v[64:67]
    v_mfma_f32_16x16x32_bf16 v[20:23], v[132:135], v[88:91], v[20:23]
    v_mfma_f32_16x16x32_bf16 v[36:39], v[132:135], v[92:95], v[36:39]
    v_mfma_f32_16x16x32_bf16 v[52:55], v[132:135], v[96:99], v[52:55]
    v_mfma_f32_16x16x32_bf16 v[68:71], v[132:135], v[100:103], v[68:71]
    s_waitcnt lgkmcnt(0)
    s_cbranch_scc1 Lcons_16
    v_mfma_f32_16x16x32_bf16 v[8:11], v[104:107], v[72:75], v[8:11]
    ds_read_b64_tr_b16 v[120:121], v138 offset:8192
    ds_read_b64_tr_b16 v[122:123], v138 offset:9216
    v_mfma_f32_16x16x32_bf16 v[24:27], v[104:107], v[76:79], v[24:27]
    ds_read_b128 v[88:91], v137 offset:0
    ds_read_b128 v[92:95], v137 offset:2048
    v_mfma_f32_16x16x32_bf16 v[40:43], v[104:107], v[80:83], v[40:43]
    ds_read_b128 v[96:99], v137 offset:4096
    ds_read_b128 v[100:103], v137 offset:6144
    v_mfma_f32_16x16x32_bf16 v[56:59], v[104:107], v[84:87], v[56:59]
    ds_read_b64_tr_b16 v[124:125], v139 offset:8192
    ds_read_b64_tr_b16 v[126:127], v139 offset:9216
    v_mfma_f32_16x16x32_bf16 v[12:15], v[108:111], v[72:75], v[12:15]
    ds_read_b64_tr_b16 v[128:129], v140 offset:8192
    ds_read_b64_tr_b16 v[130:131], v140 offset:9216
    v_mfma_f32_16x16x32_bf16 v[28:31], v[108:111], v[76:79], v[28:31]
    ds_read_b64_tr_b16 v[132:133], v141 offset:8192
    ds_read_b64_tr_b16 v[134:135], v141 offset:9216
    v_mfma_f32_16x16x32_bf16 v[44:47], v[108:111], v[80:83], v[44:47]
    v_mfma_f32_16x16x32_bf16 v[60:63], v[108:111], v[84:87], v[60:63]
    v_mfma_f32_16x16x32_bf16 v[16:19], v[112:115], v[72:75], v[16:19]
    v_mfma_f32_16x16x32_bf16 v[32:35], v[112:115], v[76:79], v[32:35]
    v_mfma_f32_16x16x32_bf16 v[48:51], v[112:115], v[80:83], v[48:51]
    v_mfma_f32_16x16x32_bf16 v[64:67], v[112:115], v[84:87], v[64:67]
    v_mfma_f32_16x16x32_bf16 v[20:23], v[116:119], v[72:75], v[20:23]
    v_mfma_f32_16x16x32_bf16 v[36:39], v[116:119], v[76:79], v[36:39]
    s_waitcnt lgkmcnt(0)
    s_barrier
    v_mfma_f32_16x16x32_bf16 v[52:55], v[116:119], v[80:83], v[52:55]
    v_mfma_f32_16x16x32_bf16 v[68:71], v[116:119], v[84:87], v[68:71]
    v_mfma_f32_16x16x32_bf16 v[8:11], v[120:123], v[88:91], v[8:11]
    v_mfma_f32_16x16x32_bf16 v[24:27], v[120:123], v[92:95], v[24:27]
    v_mfma_f32_16x16x32_bf16 v[40:43], v[120:123], v[96:99], v[40:43]
    v_mfma_f32_16x16x32_bf16 v[56:59], v[120:123], v[100:103], v[56:59]
    v_mfma_f32_16x16x32_bf16 v[12:15], v[124:127], v[88:91], v[12:15]
    v_mfma_f32_16x16x32_bf16 v[28:31], v[124:127], v[92:95], v[28:31]
    v_mfma_f32_16x16x32_bf16 v[44:47], v[124:127], v[96:99], v[44:47]
    v_mfma_f32_16x16x32_bf16 v[60:63], v[124:127], v[100:103], v[60:63]
    v_mfma_f32_16x16x32_bf16 v[16:19], v[128:131], v[88:91], v[16:19]
    v_mfma_f32_16x16x32_bf16 v[32:35], v[128:131], v[92:95], v[32:35]
    v_mfma_f32_16x16x32_bf16 v[48:51], v[128:131], v[96:99], v[48:51]
    v_mfma_f32_16x16x32_bf16 v[64:67], v[128:131], v[100:103], v[64:67]
    v_mfma_f32_16x16x32_bf16 v[20:23], v[132:135], v[88:91], v[20:23]
    v_mfma_f32_16x16x32_bf16 v[36:39], v[132:135], v[92:95], v[36:39]
    v_mfma_f32_16x16x32_bf16 v[52:55], v[132:135], v[96:99], v[52:55]
    v_mfma_f32_16x16x32_bf16 v[68:71], v[132:135], v[100:103], v[68:71]
    s_cmp_lg_u32 s20, 0
    s_cbranch_scc1 Lks1_17
    v_cvt_pk_bf16_f32 v152, v40, v41
    v_cvt_pk_bf16_f32 v153, v42, v43
    v_cvt_pk_bf16_f32 v154, v44, v45
    v_cvt_pk_bf16_f32 v155, v46, v47
    buffer_store_dwordx4 v[152:155], v2, s[56:59], s4 offen offset:0 sc1
    v_cvt_pk_bf16_f32 v156, v48, v49
    v_cvt_pk_bf16_f32 v157, v50, v51
    v_cvt_pk_bf16_f32 v158, v52, v53
    v_cvt_pk_bf16_f32 v159, v54, v55
    buffer_store_dwordx4 v[156:159], v2, s[56:59], s4 offen offset:1024 sc1
    v_cvt_pk_bf16_f32 v160, v56, v57
    v_cvt_pk_bf16_f32 v161, v58, v59
    v_cvt_pk_bf16_f32 v162, v60, v61
    v_cvt_pk_bf16_f32 v163, v62, v63
    buffer_store_dwordx4 v[160:163], v2, s[56:59], s4 offen offset:2048 sc1
    v_cvt_pk_bf16_f32 v164, v64, v65
    v_cvt_pk_bf16_f32 v165, v66, v67
    v_cvt_pk_bf16_f32 v166, v68, v69
    v_cvt_pk_bf16_f32 v167, v70, v71
    buffer_store_dwordx4 v[164:167], v2, s[56:59], s4 offen offset:3072 sc1
    s_branch Lksd_18
Lks1_17:
    v_cvt_pk_bf16_f32 v152, v8, v9
    v_cvt_pk_bf16_f32 v153, v10, v11
    v_cvt_pk_bf16_f32 v154, v12, v13
    v_cvt_pk_bf16_f32 v155, v14, v15
    buffer_store_dwordx4 v[152:155], v2, s[56:59], s4 offen offset:0 sc1
    v_cvt_pk_bf16_f32 v156, v16, v17
    v_cvt_pk_bf16_f32 v157, v18, v19
    v_cvt_pk_bf16_f32 v158, v20, v21
    v_cvt_pk_bf16_f32 v159, v22, v23
    buffer_store_dwordx4 v[156:159], v2, s[56:59], s4 offen offset:1024 sc1
    v_cvt_pk_bf16_f32 v160, v24, v25
    v_cvt_pk_bf16_f32 v161, v26, v27
    v_cvt_pk_bf16_f32 v162, v28, v29
    v_cvt_pk_bf16_f32 v163, v30, v31
    buffer_store_dwordx4 v[160:163], v2, s[56:59], s4 offen offset:2048 sc1
    v_cvt_pk_bf16_f32 v164, v32, v33
    v_cvt_pk_bf16_f32 v165, v34, v35
    v_cvt_pk_bf16_f32 v166, v36, v37
    v_cvt_pk_bf16_f32 v167, v38, v39
    buffer_store_dwordx4 v[164:167], v2, s[56:59], s4 offen offset:3072 sc1
    v_mov_b32 v8, v40
    v_mov_b32 v9, v41
    v_mov_b32 v10, v42
    v_mov_b32 v11, v43
    v_mov_b32 v12, v44
    v_mov_b32 v13, v45
    v_mov_b32 v14, v46
    v_mov_b32 v15, v47
    v_mov_b32 v16, v48
    v_mov_b32 v17, v49
    v_mov_b32 v18, v50
    v_mov_b32 v19, v51
    v_mov_b32 v20, v52
    v_mov_b32 v21, v53
    v_mov_b32 v22, v54
    v_mov_b32 v23, v55
    v_mov_b32 v24, v56
    v_mov_b32 v25, v57
    v_mov_b32 v26, v58
    v_mov_b32 v27, v59
    v_mov_b32 v28, v60
    v_mov_b32 v29, v61
    v_mov_b32 v30, v62
    v_mov_b32 v31, v63
    v_mov_b32 v32, v64
    v_mov_b32 v33, v65
    v_mov_b32 v34, v66
    v_mov_b32 v35, v67
    v_mov_b32 v36, v68
    v_mov_b32 v37, v69
    v_mov_b32 v38, v70
    v_mov_b32 v39, v71
Lksd_18:
    s_waitcnt vmcnt(0)
    s_mov_b64 exec, 1
    v_mov_b32 v216, 0
    v_mov_b32 v217, 1
    buffer_store_dword v217, v216, s[56:59], s101 offen sc1
    s_mov_b64 exec, -1
    v_sub_f32 v204, 1.0, v200
    v_cvt_pk_bf16_f32 v204, v204, v204
    v_lshlrev_b32 v204, 16, v204
    v_mov_b32 v205, v204
    v_sub_f32 v206, 1.0, v201
    v_cvt_pk_bf16_f32 v206, v206, v206
    v_lshlrev_b32 v206, 16, v206
    v_mov_b32 v207, v206
    s_mov_b32 s3, s6
    v_and_b32 v208, 0, v1
    v_lshlrev_b32 v208, 2, v208
    s_mov_b32 s7, 0
Lpf_19:
    buffer_load_dword v209, v208, s[56:59], s3 offen sc1
    s_waitcnt vmcnt(0)
    v_cmp_ne_u32 vcc, 1, v209
    s_cbranch_vccz Lpo_20
    s_sleep 1
    s_add_u32 s7, s7, 1
    s_cmp_lt_u32 s7, 262144
    s_cbranch_scc1 Lpf_19
Lpo_20:
    buffer_load_dwordx4 v[168:171], v2, s[56:59], s5 offen offset:0 sc1
    buffer_load_dwordx4 v[172:175], v2, s[56:59], s5 offen offset:1024 sc1
    buffer_load_dwordx4 v[176:179], v2, s[56:59], s5 offen offset:2048 sc1
    buffer_load_dwordx4 v[180:183], v2, s[56:59], s5 offen offset:3072 sc1
    v_mov_b32 v208, 98312
Lc4_21:
    ds_read_b32 v209, v208
    s_waitcnt lgkmcnt(0)
    v_readfirstlane_b32 s7, v209
    s_nop 0
    s_cmp_lg_u32 s7, 0
    s_cbranch_scc0 Lc4_21
    s_mov_b32 s22, 41943040
    s_mov_b32 s23, 41975808
    buffer_load_dwordx2 v[184:185], v6, s[56:59], s22 offen offset:0 sc1
    buffer_load_dwordx2 v[186:187], v6, s[56:59], s22 offen offset:32 sc1
    buffer_load_dwordx2 v[188:189], v6, s[56:59], s22 offen offset:64 sc1
    buffer_load_dwordx2 v[190:191], v6, s[56:59], s22 offen offset:96 sc1
    buffer_load_dwordx2 v[192:193], v6, s[56:59], s23 offen offset:0 sc1
    buffer_load_dwordx2 v[194:195], v6, s[56:59], s23 offen offset:32 sc1
    buffer_load_dwordx2 v[196:197], v6, s[56:59], s23 offen offset:64 sc1
    buffer_load_dwordx2 v[198:199], v6, s[56:59], s23 offen offset:96 sc1
    s_mov_b32 s22, 0
    s_mov_b32 s23, 32768
    s_waitcnt vmcnt(6)
    v_lshlrev_b32 v212, 16, v168
    v_and_b32 v213, 0xffff0000, v168
    v_lshlrev_b32 v214, 16, v184
    v_and_b32 v215, 0xffff0000, v184
    v_lshlrev_b32 v216, 16, v169
    v_and_b32 v217, 0xffff0000, v169
    v_lshlrev_b32 v218, 16, v185
    v_and_b32 v219, 0xffff0000, v185
    v_lshlrev_b32 v220, 16, v170
    v_and_b32 v221, 0xffff0000, v170
    v_lshlrev_b32 v222, 16, v186
    v_and_b32 v223, 0xffff0000, v186
    v_lshlrev_b32 v224, 16, v171
    v_and_b32 v225, 0xffff0000, v171
    v_lshlrev_b32 v226, 16, v187
    v_and_b32 v227, 0xffff0000, v187
    v_pk_add_f32 v[8:9], v[8:9], v[212:213]
    v_pk_add_f32 v[10:11], v[10:11], v[216:217]
    v_pk_add_f32 v[12:13], v[12:13], v[220:221]
    v_pk_add_f32 v[14:15], v[14:15], v[224:225]
    v_pk_fma_f32 v[8:9], v[8:9], v[204:205], v[214:215]
    v_pk_fma_f32 v[10:11], v[10:11], v[204:205], v[218:219]
    v_pk_fma_f32 v[12:13], v[12:13], v[204:205], v[222:223]
    v_pk_fma_f32 v[14:15], v[14:15], v[204:205], v[226:227]
    v_cvt_pk_bf16_f32 v152, v8, v9
    v_cvt_pk_bf16_f32 v153, v10, v11
    v_cvt_pk_bf16_f32 v154, v12, v13
    v_cvt_pk_bf16_f32 v155, v14, v15
    s_nop 0
    v_permlane16_swap_b32 v152, v154
    v_permlane16_swap_b32 v153, v155
    buffer_store_dwordx4 v[152:155], v7, s[64:67], s22 offen offset:0 sc1
    s_waitcnt vmcnt(5)
    v_lshlrev_b32 v228, 16, v172
    v_and_b32 v229, 0xffff0000, v172
    v_lshlrev_b32 v230, 16, v188
    v_and_b32 v231, 0xffff0000, v188
    v_lshlrev_b32 v232, 16, v173
    v_and_b32 v233, 0xffff0000, v173
    v_lshlrev_b32 v234, 16, v189
    v_and_b32 v235, 0xffff0000, v189
    v_lshlrev_b32 v236, 16, v174
    v_and_b32 v237, 0xffff0000, v174
    v_lshlrev_b32 v238, 16, v190
    v_and_b32 v239, 0xffff0000, v190
    v_lshlrev_b32 v240, 16, v175
    v_and_b32 v241, 0xffff0000, v175
    v_lshlrev_b32 v242, 16, v191
    v_and_b32 v243, 0xffff0000, v191
    v_pk_add_f32 v[16:17], v[16:17], v[228:229]
    v_pk_add_f32 v[18:19], v[18:19], v[232:233]
    v_pk_add_f32 v[20:21], v[20:21], v[236:237]
    v_pk_add_f32 v[22:23], v[22:23], v[240:241]
    v_pk_fma_f32 v[16:17], v[16:17], v[204:205], v[230:231]
    v_pk_fma_f32 v[18:19], v[18:19], v[204:205], v[234:235]
    v_pk_fma_f32 v[20:21], v[20:21], v[204:205], v[238:239]
    v_pk_fma_f32 v[22:23], v[22:23], v[204:205], v[242:243]
    v_cvt_pk_bf16_f32 v156, v16, v17
    v_cvt_pk_bf16_f32 v157, v18, v19
    v_cvt_pk_bf16_f32 v158, v20, v21
    v_cvt_pk_bf16_f32 v159, v22, v23
    s_nop 0
    v_permlane16_swap_b32 v156, v158
    v_permlane16_swap_b32 v157, v159
    buffer_store_dwordx4 v[156:159], v7, s[64:67], s22 offen offset:64 sc1
    s_waitcnt vmcnt(4)
    v_lshlrev_b32 v212, 16, v176
    v_and_b32 v213, 0xffff0000, v176
    v_lshlrev_b32 v214, 16, v192
    v_and_b32 v215, 0xffff0000, v192
    v_lshlrev_b32 v216, 16, v177
    v_and_b32 v217, 0xffff0000, v177
    v_lshlrev_b32 v218, 16, v193
    v_and_b32 v219, 0xffff0000, v193
    v_lshlrev_b32 v220, 16, v178
    v_and_b32 v221, 0xffff0000, v178
    v_lshlrev_b32 v222, 16, v194
    v_and_b32 v223, 0xffff0000, v194
    v_lshlrev_b32 v224, 16, v179
    v_and_b32 v225, 0xffff0000, v179
    v_lshlrev_b32 v226, 16, v195
    v_and_b32 v227, 0xffff0000, v195
    v_pk_add_f32 v[24:25], v[24:25], v[212:213]
    v_pk_add_f32 v[26:27], v[26:27], v[216:217]
    v_pk_add_f32 v[28:29], v[28:29], v[220:221]
    v_pk_add_f32 v[30:31], v[30:31], v[224:225]
    v_pk_fma_f32 v[24:25], v[24:25], v[206:207], v[214:215]
    v_pk_fma_f32 v[26:27], v[26:27], v[206:207], v[218:219]
    v_pk_fma_f32 v[28:29], v[28:29], v[206:207], v[222:223]
    v_pk_fma_f32 v[30:31], v[30:31], v[206:207], v[226:227]
    v_cvt_pk_bf16_f32 v160, v24, v25
    v_cvt_pk_bf16_f32 v161, v26, v27
    v_cvt_pk_bf16_f32 v162, v28, v29
    v_cvt_pk_bf16_f32 v163, v30, v31
    s_nop 0
    v_permlane16_swap_b32 v160, v162
    v_permlane16_swap_b32 v161, v163
    buffer_store_dwordx4 v[160:163], v7, s[64:67], s23 offen offset:0 sc1
    s_waitcnt vmcnt(3)
    v_lshlrev_b32 v228, 16, v180
    v_and_b32 v229, 0xffff0000, v180
    v_lshlrev_b32 v230, 16, v196
    v_and_b32 v231, 0xffff0000, v196
    v_lshlrev_b32 v232, 16, v181
    v_and_b32 v233, 0xffff0000, v181
    v_lshlrev_b32 v234, 16, v197
    v_and_b32 v235, 0xffff0000, v197
    v_lshlrev_b32 v236, 16, v182
    v_and_b32 v237, 0xffff0000, v182
    v_lshlrev_b32 v238, 16, v198
    v_and_b32 v239, 0xffff0000, v198
    v_lshlrev_b32 v240, 16, v183
    v_and_b32 v241, 0xffff0000, v183
    v_lshlrev_b32 v242, 16, v199
    v_and_b32 v243, 0xffff0000, v199
    v_pk_add_f32 v[32:33], v[32:33], v[228:229]
    v_pk_add_f32 v[34:35], v[34:35], v[232:233]
    v_pk_add_f32 v[36:37], v[36:37], v[236:237]
    v_pk_add_f32 v[38:39], v[38:39], v[240:241]
    v_pk_fma_f32 v[32:33], v[32:33], v[206:207], v[230:231]
    v_pk_fma_f32 v[34:35], v[34:35], v[206:207], v[234:235]
    v_pk_fma_f32 v[36:37], v[36:37], v[206:207], v[238:239]
    v_pk_fma_f32 v[38:39], v[38:39], v[206:207], v[242:243]
    v_cvt_pk_bf16_f32 v164, v32, v33
    v_cvt_pk_bf16_f32 v165, v34, v35
    v_cvt_pk_bf16_f32 v166, v36, v37
    v_cvt_pk_bf16_f32 v167, v38, v39
    s_nop 0
    v_permlane16_swap_b32 v164, v166
    v_permlane16_swap_b32 v165, v167
    buffer_store_dwordx4 v[164:167], v7, s[64:67], s23 offen offset:64 sc1
    s_endpgm
Lload_2:
    s_mov_b32 s8, s32
    s_mov_b32 s9, s33
    s_mov_b32 s10, 4194304
    s_mov_b32 s11, 0x20000
    s_mov_b32 s12, s40
    s_mov_b32 s13, s41
    s_mov_b32 s14, 7340032
    s_mov_b32 s15, 0x20000
    s_mul_i32 s70, s28, 32
    s_add_u32 s70, s70, s29
    s_mul_i32 s70, s70, 2048
    s_lshl_b32 s71, s31, 1
    s_add_u32 s70, s70, s71
    s_mov_b32 s72, 2048
    v_lshrrev_b32 v13, 3, v1
    v_mul_lo_u32 v14, v13, s72
    v_add_u32 v14, s70, v14
    v_lshrrev_b32 v15, 4, v1
    v_xor_b32 v15, v15, v1
    v_and_b32 v15, 7, v15
    v_lshlrev_b32 v15, 4, v15
    v_add_u32 v2, v14, v15
    v_lshrrev_b32 v15, 4, v1
    v_add_u32 v15, 4, v15
    v_xor_b32 v15, v15, v1
    v_and_b32 v15, 7, v15
    v_lshlrev_b32 v15, 4, v15
    v_add_u32 v3, v14, v15
    v_add_u32 v3, 15360, v3
    v_lshrrev_b32 v15, 4, v1
    v_xor_b32 v15, v15, v1
    v_and_b32 v15, 7, v15
    v_lshlrev_b32 v15, 4, v15
    v_add_u32 v4, v14, v15
    v_add_u32 v4, 30720, v4
    v_lshrrev_b32 v15, 4, v1
    v_add_u32 v15, 4, v15
    v_xor_b32 v15, v15, v1
    v_and_b32 v15, 7, v15
    v_lshlrev_b32 v15, 4, v15
    v_add_u32 v5, v14, v15
    v_add_u32 v5, 46080, v5
    s_lshl_b32 s70, s28, 4
    s_add_u32 s70, s70, s31
    s_mul_i32 s70, s70, 7168
    s_lshl_b32 s71, s30, 1
    s_add_u32 s70, s70, s71
    s_mov_b32 s72, 7168
    v_add_u32 v13, 0, v1
    v_mul_u32_u24 v14, 2341, v13
    v_lshrrev_b32 v14, 16, v14
    v_mul_u32_u24 v15, 28, v14
    v_sub_u32 v13, v13, v15
    v_lshrrev_b32 v15, 2, v14
    v_and_b32 v15, 2, v15
    v_xor_b32 v13, v13, v15
    v_lshlrev_b32 v13, 4, v13
    v_mul_lo_u32 v14, v14, s72
    v_add3_u32 v6, v13, v14, s70
    v_add_u32 v13, 64, v1
    v_mul_u32_u24 v14, 2341, v13
    v_lshrrev_b32 v14, 16, v14
    v_mul_u32_u24 v15, 28, v14
    v_sub_u32 v13, v13, v15
    v_lshrrev_b32 v15, 2, v14
    v_and_b32 v15, 2, v15
    v_xor_b32 v13, v13, v15
    v_lshlrev_b32 v13, 4, v13
    v_mul_lo_u32 v14, v14, s72
    v_add3_u32 v7, v13, v14, s70
    v_subrev_u32 v7, 1024, v7
    v_add_u32 v13, 128, v1
    v_mul_u32_u24 v14, 2341, v13
    v_lshrrev_b32 v14, 16, v14
    v_mul_u32_u24 v15, 28, v14
    v_sub_u32 v13, v13, v15
    v_lshrrev_b32 v15, 2, v14
    v_and_b32 v15, 2, v15
    v_xor_b32 v13, v13, v15
    v_lshlrev_b32 v13, 4, v13
    v_mul_lo_u32 v14, v14, s72
    v_add3_u32 v8, v13, v14, s70
    v_subrev_u32 v8, 2048, v8
    v_add_u32 v13, 192, v1
    v_mul_u32_u24 v14, 2341, v13
    v_lshrrev_b32 v14, 16, v14
    v_mul_u32_u24 v15, 28, v14
    v_sub_u32 v13, v13, v15
    v_lshrrev_b32 v15, 2, v14
    v_and_b32 v15, 2, v15
    v_xor_b32 v13, v13, v15
    v_lshlrev_b32 v13, 4, v13
    v_mul_lo_u32 v14, v14, s72
    v_add3_u32 v9, v13, v14, s70
    v_subrev_u32 v9, 3072, v9
    v_add_u32 v13, 256, v1
    v_mul_u32_u24 v14, 2341, v13
    v_lshrrev_b32 v14, 16, v14
    v_mul_u32_u24 v15, 28, v14
    v_sub_u32 v13, v13, v15
    v_lshrrev_b32 v15, 2, v14
    v_and_b32 v15, 2, v15
    v_xor_b32 v13, v13, v15
    v_lshlrev_b32 v13, 4, v13
    v_mul_lo_u32 v14, v14, s72
    v_add3_u32 v10, v13, v14, s70
    v_add_u32 v13, 320, v1
    v_mul_u32_u24 v14, 2341, v13
    v_lshrrev_b32 v14, 16, v14
    v_mul_u32_u24 v15, 28, v14
    v_sub_u32 v13, v13, v15
    v_lshrrev_b32 v15, 2, v14
    v_and_b32 v15, 2, v15
    v_xor_b32 v13, v13, v15
    v_lshlrev_b32 v13, 4, v13
    v_mul_lo_u32 v14, v14, s72
    v_add3_u32 v11, v13, v14, s70
    v_subrev_u32 v11, 1024, v11
    v_add_u32 v13, 384, v1
    v_mul_u32_u24 v14, 2341, v13
    v_lshrrev_b32 v14, 16, v14
    v_mul_u32_u24 v15, 28, v14
    v_sub_u32 v13, v13, v15
    v_lshrrev_b32 v15, 2, v14
    v_and_b32 v15, 2, v15
    v_xor_b32 v13, v13, v15
    v_lshlrev_b32 v13, 4, v13
    v_mul_lo_u32 v14, v14, s72
    v_add3_u32 v12, v13, v14, s70
    v_subrev_u32 v12, 2048, v12
    s_mul_i32 s74, s28, 4096
    s_mul_i32 s75, s28, 7168
    s_add_u32 s75, s75, 16384
    s_mov_b32 s16, 0
    s_mov_b32 s17, 0
    s_mov_b32 s18, 0
    s_mov_b32 s16, 128
    s_mov_b32 s17, 458752
    s_mov_b32 s18, 45056
    s_bitcmp1_b32 s2, 0
    s_cbranch_scc0 Lb_22
    s_waitcnt vmcnt(0)
Lb_22:
    s_add_u32 m0, s18, s74
    s_nop 0
    buffer_load_dwordx4 v2, s[8:11], s16 offen offset:0 lds
    buffer_load_dwordx4 v3, s[8:11], s16 offen offset:1024 lds
    buffer_load_dwordx4 v4, s[8:11], s16 offen offset:2048 lds
    buffer_load_dwordx4 v5, s[8:11], s16 offen offset:3072 lds
    s_add_u32 m0, s18, s75
    s_nop 0
    buffer_load_dwordx4 v6, s[12:15], s17 offen offset:0 lds
    buffer_load_dwordx4 v7, s[12:15], s17 offen offset:1024 lds
    buffer_load_dwordx4 v8, s[12:15], s17 offen offset:2048 lds
    buffer_load_dwordx4 v9, s[12:15], s17 offen offset:3072 lds
    s_add_u32 m0, m0, 4096
    s_nop 0
    buffer_load_dwordx4 v10, s[12:15], s17 offen offset:0 lds
    buffer_load_dwordx4 v11, s[12:15], s17 offen offset:1024 lds
    buffer_load_dwordx4 v12, s[12:15], s17 offen offset:2048 lds
    s_add_u32 s16, s16, 128
    s_add_u32 s17, s17, 458752
    s_add_u32 s18, s18, 45056
    s_cmp_eq_u32 s18, 135168
    s_cselect_b32 s18, 0, s18
    s_mov_b32 s68, s2
    v_and_b32 v16, 15, v1
    v_lshrrev_b32 v17, 4, v1
    v_cvt_f32_u32 v18, v16
    v_lshlrev_b32 v19, 2, v17
    v_cvt_f32_u32 v19, v19
    v_lshrrev_b32 v100, 2, v1
    v_lshlrev_b32 v100, 7, v100
    v_and_b32 v101, 3, v1
    v_lshl_add_u32 v100, v101, 4, v100
    s_lshr_b32 s3, s68, 1
    s_lshl_b32 s3, s3, 15
    s_and_b32 s4, s68, 1
    s_lshl_b32 s4, s4, 6
    s_add_u32 s3, s3, s4
    s_lshl_b32 s4, s28, 13
    s_add_u32 s20, s3, s4
    s_add_u32 s20, s20, 16777216
    s_add_u32 s21, s20, 4096
    v_and_b32 v102, 1, v1
    v_lshlrev_b32 v102, 13, v102
    v_lshrrev_b32 v101, 5, v1
    v_lshl_add_u32 v102, v101, 12, v102
    v_bfe_u32 v101, v1, 1, 4
    v_lshl_add_u32 v102, v101, 4, v102
    s_lshl_b32 s4, s28, 10
    s_add_u32 s4, s4, 135168
    v_add_u32 v102, s4, v102
    v_lshlrev_b32 v101, 11, v17
    v_bfe_u32 v84, v1, 3, 1
    v_lshl_add_u32 v101, v84, 7, v101
    v_and_b32 v84, 7, v1
    v_lshl_add_u32 v101, v84, 3, v101
    s_lshl_b32 s4, s28, 8
    s_add_u32 s4, s4, s3
    s_add_u32 s4, s4, 20971520
    s_lshl_b32 s5, s28, 4
    v_add_u32 v250, s5, v16
    v_cvt_f32_u32 v250, v250
    v_and_b32 v251, 1, v1
    v_mul_u32_u24 v251, 0x8000, v251
    v_lshl_or_b32 v251, v251, 16, v251
    v_mul_f32 v248, 0x3c800000, v250
    v_mul_f32 v249, v19, v248
    v_mov_b32 v233, v249
    v_fmamk_f32 v235, v248, 0x3f800000, v249
    v_fmamk_f32 v237, v248, 0x40000000, v249
    v_fmamk_f32 v239, v248, 0x40400000, v249
    v_fmamk_f32 v241, v248, 0x41800000, v249
    v_fmamk_f32 v243, v248, 0x41880000, v249
    v_fmamk_f32 v245, v248, 0x41900000, v249
    v_fmamk_f32 v247, v248, 0x41980000, v249
    v_cos_f32 v232, v233
    v_sin_f32 v233, v233
    v_cos_f32 v234, v235
    v_sin_f32 v235, v235
    v_cos_f32 v236, v237
    v_sin_f32 v237, v237
    v_cos_f32 v238, v239
    v_sin_f32 v239, v239
    v_cos_f32 v240, v241
    v_sin_f32 v241, v241
    v_cos_f32 v242, v243
    v_sin_f32 v243, v243
    v_cos_f32 v244, v245
    v_sin_f32 v245, v245
    v_cos_f32 v246, v247
    v_sin_f32 v247, v247
    v_cvt_pk_bf16_f32 v104, v232, v233
    v_cvt_pk_bf16_f32 v108, -v233, v232
    v_cvt_pk_bf16_f32 v105, v234, v235
    v_cvt_pk_bf16_f32 v109, -v235, v234
    v_cvt_pk_bf16_f32 v106, v236, v237
    v_cvt_pk_bf16_f32 v110, -v237, v236
    v_cvt_pk_bf16_f32 v107, v238, v239
    v_cvt_pk_bf16_f32 v111, -v239, v238
    v_xor_b32 v120, v251, v104
    v_xor_b32 v121, v251, v105
    v_xor_b32 v122, v251, v106
    v_xor_b32 v123, v251, v107
    v_xor_b32 v124, v251, v108
    v_xor_b32 v125, v251, v109
    v_xor_b32 v126, v251, v110
    v_xor_b32 v127, v251, v111
    v_cvt_pk_bf16_f32 v112, v240, v241
    v_cvt_pk_bf16_f32 v116, -v241, v240
    v_cvt_pk_bf16_f32 v113, v242, v243
    v_cvt_pk_bf16_f32 v117, -v243, v242
    v_cvt_pk_bf16_f32 v114, v244, v245
    v_cvt_pk_bf16_f32 v118, -v245, v244
    v_cvt_pk_bf16_f32 v115, v246, v247
    v_cvt_pk_bf16_f32 v119, -v247, v246
    v_xor_b32 v128, v251, v112
    v_xor_b32 v129, v251, v113
    v_xor_b32 v130, v251, v114
    v_xor_b32 v131, v251, v115
    v_xor_b32 v132, v251, v116
    v_xor_b32 v133, v251, v117
    v_xor_b32 v134, v251, v118
    v_xor_b32 v135, v251, v119
    v_mul_f32 v248, 0x3a000000, v250
    v_mul_f32 v249, v19, v248
    v_mov_b32 v137, v249
    v_fmamk_f32 v139, v248, 0x3f800000, v249
    v_fmamk_f32 v141, v248, 0x40000000, v249
    v_fmamk_f32 v143, v248, 0x40400000, v249
    v_fmamk_f32 v145, v248, 0x41800000, v249
    v_fmamk_f32 v147, v248, 0x41880000, v249
    v_fmamk_f32 v149, v248, 0x41900000, v249
    v_fmamk_f32 v151, v248, 0x41980000, v249
    v_cos_f32 v136, v137
    v_sin_f32 v137, v137
    v_cos_f32 v138, v139
    v_sin_f32 v139, v139
    v_cos_f32 v140, v141
    v_sin_f32 v141, v141
    v_cos_f32 v142, v143
    v_sin_f32 v143, v143
    v_cos_f32 v144, v145
    v_sin_f32 v145, v145
    v_cos_f32 v146, v147
    v_sin_f32 v147, v147
    v_cos_f32 v148, v149
    v_sin_f32 v149, v149
    v_cos_f32 v150, v151
    v_sin_f32 v151, v151
    v_lshrrev_b32 v248, 1, v16
    v_cvt_f32_u32 v248, v248
    v_mul_f32 v248, 0x3d000000, v248
    v_and_b32 v249, 1, v1
    v_cvt_f32_u32 v249, v249
    v_mul_f32 v249, 0x3e800000, v249
    v_fmac_f32 v249, v19, v248
    v_mov_b32 v233, v249
    v_fmamk_f32 v235, v248, 0x3f800000, v249
    v_fmamk_f32 v237, v248, 0x40000000, v249
    v_fmamk_f32 v239, v248, 0x40400000, v249
    v_cos_f32 v232, v233
    v_sin_f32 v233, v233
    v_cos_f32 v234, v235
    v_sin_f32 v235, v235
    v_cos_f32 v236, v237
    v_sin_f32 v237, v237
    v_cos_f32 v238, v239
    v_sin_f32 v239, v239
    v_bfe_u32 v252, v1, 1, 1
    v_mul_u32_u24 v252, 0x8000, v252
    v_lshl_or_b32 v252, v252, 16, v252
    v_cvt_pk_bf16_f32 v152, v232, v233
    v_cvt_pk_bf16_f32 v153, v234, v235
    v_cvt_pk_bf16_f32 v154, v236, v237
    v_cvt_pk_bf16_f32 v155, v238, v239
    v_xor_b32 v156, v252, v152
    v_xor_b32 v157, v252, v153
    v_xor_b32 v158, v252, v154
    v_xor_b32 v159, v252, v155
    v_cvt_pk_bf16_f32 v160, v232, v233
    v_cvt_pk_bf16_f32 v161, -v235, v234
    v_cvt_pk_bf16_f32 v162, -v236, -v237
    v_cvt_pk_bf16_f32 v163, v239, -v238
    v_xor_b32 v164, v252, v160
    v_xor_b32 v165, v252, v161
    v_xor_b32 v166, v252, v162
    v_xor_b32 v167, v252, v163
    v_cvt_pk_bf16_f32 v168, v232, v233
    v_cvt_pk_bf16_f32 v169, -v234, -v235
    v_cvt_pk_bf16_f32 v170, v236, v237
    v_cvt_pk_bf16_f32 v171, -v238, -v239
    v_xor_b32 v172, v252, v168
    v_xor_b32 v173, v252, v169
    v_xor_b32 v174, v252, v170
    v_xor_b32 v175, v252, v171
    v_cvt_pk_bf16_f32 v176, v232, v233
    v_cvt_pk_bf16_f32 v177, v235, -v234
    v_cvt_pk_bf16_f32 v178, -v236, -v237
    v_cvt_pk_bf16_f32 v179, -v239, v238
    v_xor_b32 v180, v252, v176
    v_xor_b32 v181, v252, v177
    v_xor_b32 v182, v252, v178
    v_xor_b32 v183, v252, v179
    s_waitcnt vmcnt(11)
    s_barrier
    s_cmp_lg_u32 s28, 0
    s_cbranch_scc1 Lw0_23
    s_mov_b64 exec, 1
    v_mov_b32 v13, 0
    v_mov_b32 v14, 1
    global_atomic_add v13, v14, s[52:53] sc1
    s_mov_b64 exec, -1
Lw0_23:
    s_add_u32 m0, s18, s74
    s_nop 0
    buffer_load_dwordx4 v2, s[8:11], s16 offen offset:0 lds
    buffer_load_dwordx4 v3, s[8:11], s16 offen offset:1024 lds
    buffer_load_dwordx4 v4, s[8:11], s16 offen offset:2048 lds
    buffer_load_dwordx4 v5, s[8:11], s16 offen offset:3072 lds
    s_add_u32 m0, s18, s75
    s_nop 0
    buffer_load_dwordx4 v6, s[12:15], s17 offen offset:0 lds
    buffer_load_dwordx4 v7, s[12:15], s17 offen offset:1024 lds
    buffer_load_dwordx4 v8, s[12:15], s17 offen offset:2048 lds
    buffer_load_dwordx4 v9, s[12:15], s17 offen offset:3072 lds
    s_add_u32 m0, m0, 4096
    s_nop 0
    buffer_load_dwordx4 v10, s[12:15], s17 offen offset:0 lds
    buffer_load_dwordx4 v11, s[12:15], s17 offen offset:1024 lds
    buffer_load_dwordx4 v12, s[12:15], s17 offen offset:2048 lds
    s_add_u32 s16, s16, 128
    s_add_u32 s17, s17, 458752
    s_add_u32 s18, s18, 45056
    s_cmp_eq_u32 s18, 135168
    s_cselect_b32 s18, 0, s18
    s_mov_b32 s19, 13
Lld_24:
    s_waitcnt vmcnt(11)
    s_barrier
    s_add_u32 m0, s18, s74
    s_nop 0
    buffer_load_dwordx4 v2, s[8:11], s16 offen offset:0 lds
    buffer_load_dwordx4 v3, s[8:11], s16 offen offset:1024 lds
    buffer_load_dwordx4 v4, s[8:11], s16 offen offset:2048 lds
    buffer_load_dwordx4 v5, s[8:11], s16 offen offset:3072 lds
    s_add_u32 m0, s18, s75
    s_nop 0
    buffer_load_dwordx4 v6, s[12:15], s17 offen offset:0 lds
    buffer_load_dwordx4 v7, s[12:15], s17 offen offset:1024 lds
    buffer_load_dwordx4 v8, s[12:15], s17 offen offset:2048 lds
    buffer_load_dwordx4 v9, s[12:15], s17 offen offset:3072 lds
    s_add_u32 m0, m0, 4096
    s_nop 0
    buffer_load_dwordx4 v10, s[12:15], s17 offen offset:0 lds
    buffer_load_dwordx4 v11, s[12:15], s17 offen offset:1024 lds
    buffer_load_dwordx4 v12, s[12:15], s17 offen offset:2048 lds
    s_add_u32 s16, s16, 128
    s_add_u32 s17, s17, 458752
    s_add_u32 s18, s18, 45056
    s_cmp_eq_u32 s18, 135168
    s_cselect_b32 s18, 0, s18
    s_sub_u32 s19, s19, 1
    s_cmp_lg_u32 s19, 0
    s_cbranch_scc1 Lld_24
    s_cmp_lg_u32 s28, 0
    s_cbranch_scc1 Lnp_25
    v_mov_b32 v13, 0
    s_mov_b32 s78, 0
Lpd_26:
    global_load_dword v14, v13, s[52:53] sc1
    s_waitcnt vmcnt(0)
    v_readfirstlane_b32 s79, v14
    s_nop 0
    s_cmp_ge_u32 s79, 256
    s_cbranch_scc1 Lpo_27
    s_sleep 2
    s_add_u32 s78, s78, 1
    s_cmp_lt_u32 s78, 262144
    s_cbranch_scc1 Lpd_26
Lpo_27:
Lnp_25:
    s_waitcnt vmcnt(11)
    s_barrier
    buffer_load_dwordx4 v[20:23], v100, s[56:59], s20 offen offset:0 sc1
    buffer_load_dwordx4 v[24:27], v100, s[56:59], s20 offen offset:2048 sc1
    buffer_load_dwordx4 v[28:31], v100, s[56:59], s21 offen offset:0 sc1
    buffer_load_dwordx4 v[32:35], v100, s[56:59], s21 offen offset:2048 sc1
    buffer_load_dwordx2 v[84:85], v101, s[56:59], s4 offen offset:0 sc1
    buffer_load_dwordx2 v[86:87], v101, s[56:59], s4 offen offset:1024 sc1
    s_add_u32 s22, s4, 8192
    buffer_load_dwordx2 v[88:89], v101, s[56:59], s22 offen offset:0 sc1
    buffer_load_dwordx2 v[90:91], v101, s[56:59], s22 offen offset:1024 sc1
    s_add_u32 s22, s4, 16384
    buffer_load_dwordx2 v[92:93], v101, s[56:59], s22 offen offset:0 sc1
    buffer_load_dwordx2 v[94:95], v101, s[56:59], s22 offen offset:1024 sc1
    s_add_u32 s22, s4, 24576
    buffer_load_dwordx2 v[96:97], v101, s[56:59], s22 offen offset:0 sc1
    buffer_load_dwordx2 v[98:99], v101, s[56:59], s22 offen offset:1024 sc1
    s_waitcnt vmcnt(12)
    s_barrier
    s_and_b32 s78, s83, 7
    s_lshl_b32 s30, s78, 7
    s_lshr_b32 s78, s83, 3
    s_mul_i32 s31, s78, 1792

    s_mov_b32 s12, s44
    s_mov_b32 s13, s45
    s_mov_b32 s14, 7340032
    s_mov_b32 s15, 0x20000
    s_mov_b32 s8, s56
    s_mov_b32 s9, s57
    s_mov_b32 s10, 15728640
    s_mul_i32 s70, s28, 32
    s_add_u32 s70, s70, s29
    s_lshr_b32 s70, s70, 4
    s_mul_i32 s70, s70, 114688
    s_lshl_b32 s71, s31, 5
    s_add_u32 s70, s70, s71
    s_add_u32 s70, s70, 1048576
    v_lshrrev_b32 v10, 3, v1
    v_lshlrev_b32 v11, 6, v10
    v_add_u32 v11, s70, v11
    v_lshrrev_b32 v12, 4, v1
    v_xor_b32 v12, v12, v1
    v_and_b32 v2, 4, v12
    v_lshlrev_b32 v2, 8, v2
    v_and_b32 v12, 3, v12
    v_lshlrev_b32 v12, 4, v12
    v_add3_u32 v2, v2, v11, v12
    v_lshrrev_b32 v12, 4, v1
    v_add_u32 v12, 4, v12
    v_xor_b32 v12, v12, v1
    v_and_b32 v3, 4, v12
    v_lshlrev_b32 v3, 8, v3
    v_and_b32 v12, 3, v12
    v_lshlrev_b32 v12, 4, v12
    v_add3_u32 v3, v3, v11, v12
    v_add_u32 v3, 4294966784, v3
    v_lshrrev_b32 v12, 4, v1
    v_xor_b32 v12, v12, v1
    v_and_b32 v4, 4, v12
    v_lshlrev_b32 v4, 8, v4
    v_and_b32 v12, 3, v12
    v_lshlrev_b32 v12, 4, v12
    v_add3_u32 v4, v4, v11, v12
    v_add_u32 v4, 112640, v4
    v_lshrrev_b32 v12, 4, v1
    v_add_u32 v12, 4, v12
    v_xor_b32 v12, v12, v1
    v_and_b32 v5, 4, v12
    v_lshlrev_b32 v5, 8, v5
    v_and_b32 v12, 3, v12
    v_lshlrev_b32 v12, 4, v12
    v_add3_u32 v5, v5, v11, v12
    v_add_u32 v5, 112128, v5
    s_lshl_b32 s70, s28, 4
    s_add_u32 s70, s70, s31
    s_mul_i32 s70, s70, 2048
    s_lshl_b32 s71, s30, 1
    s_add_u32 s70, s70, s71
    s_mov_b32 s72, 2048
    v_add_u32 v10, 0, v1
    v_mul_u32_u24 v11, 4096, v10
    v_lshrrev_b32 v11, 16, v11
    v_mul_u32_u24 v12, 16, v11
    v_sub_u32 v10, v10, v12
    v_and_b32 v12, 3, v11
    v_lshlrev_b32 v12, 1, v12
    v_and_b32 v6, 8, v11
    v_or_b32 v12, v12, v6
    v_xor_b32 v10, v10, v12
    v_lshlrev_b32 v10, 4, v10
    v_mul_lo_u32 v11, v11, s72
    v_add3_u32 v6, v10, v11, s70
    v_add_u32 v10, 64, v1
    v_mul_u32_u24 v11, 4096, v10
    v_lshrrev_b32 v11, 16, v11
    v_mul_u32_u24 v12, 16, v11
    v_sub_u32 v10, v10, v12
    v_and_b32 v12, 3, v11
    v_lshlrev_b32 v12, 1, v12
    v_and_b32 v7, 8, v11
    v_or_b32 v12, v12, v7
    v_xor_b32 v10, v10, v12
    v_lshlrev_b32 v10, 4, v10
    v_mul_lo_u32 v11, v11, s72
    v_add3_u32 v7, v10, v11, s70
    v_subrev_u32 v7, 1024, v7
    v_add_u32 v10, 128, v1
    v_mul_u32_u24 v11, 4096, v10
    v_lshrrev_b32 v11, 16, v11
    v_mul_u32_u24 v12, 16, v11
    v_sub_u32 v10, v10, v12
    v_and_b32 v12, 3, v11
    v_lshlrev_b32 v12, 1, v12
    v_and_b32 v8, 8, v11
    v_or_b32 v12, v12, v8
    v_xor_b32 v10, v10, v12
    v_lshlrev_b32 v10, 4, v10
    v_mul_lo_u32 v11, v11, s72
    v_add3_u32 v8, v10, v11, s70
    v_subrev_u32 v8, 2048, v8
    v_add_u32 v10, 192, v1
    v_mul_u32_u24 v11, 4096, v10
    v_lshrrev_b32 v11, 16, v11
    v_mul_u32_u24 v12, 16, v11
    v_sub_u32 v10, v10, v12
    v_and_b32 v12, 3, v11
    v_lshlrev_b32 v12, 1, v12
    v_and_b32 v9, 8, v11
    v_or_b32 v12, v12, v9
    v_xor_b32 v10, v10, v12
    v_lshlrev_b32 v10, 4, v10
    v_mul_lo_u32 v11, v11, s72
    v_add3_u32 v9, v10, v11, s70
    v_subrev_u32 v9, 3072, v9
    s_mul_i32 s74, s28, 4096
    s_mul_i32 s75, s28, 4096
    s_add_u32 s75, s75, 16384
    s_mov_b32 s16, 0
    s_mov_b32 s17, 0
    s_mov_b32 s18, 0
    s_and_b32 s19, s83, 7
    s_mul_i32 s19, s19, 7
    s_add_u32 s19, s19, 1
    s_lshr_b32 s81, s19, 1
    s_waitcnt vmcnt(11)
    ds_write_b128 v102, v[20:23] offset:0
    s_waitcnt vmcnt(10)
    ds_write_b128 v102, v[24:27] offset:256
    s_waitcnt vmcnt(9)
    ds_write_b128 v102, v[28:31] offset:512
    s_waitcnt vmcnt(8)
    ds_write_b128 v102, v[32:35] offset:768
    v_lshlrev_b32 v102, 4, v1
    v_add_u32 v102, 135168, v102
    s_waitcnt lgkmcnt(0)
    s_barrier
    s_add_u32 s78, s81, 0
    s_lshl_b32 s17, s78, 17
    s_add_u32 m0, s75, 0
    s_nop 0
    buffer_load_dwordx4 v6, s[12:15], s17 offen offset:0 lds
    buffer_load_dwordx4 v7, s[12:15], s17 offen offset:1024 lds
    buffer_load_dwordx4 v8, s[12:15], s17 offen offset:2048 lds
    buffer_load_dwordx4 v9, s[12:15], s17 offen offset:3072 lds
    s_add_u32 s78, s81, 1
    s_lshl_b32 s17, s78, 17
    s_add_u32 m0, s75, 32768
    s_nop 0
    buffer_load_dwordx4 v6, s[12:15], s17 offen offset:0 lds
    buffer_load_dwordx4 v7, s[12:15], s17 offen offset:1024 lds
    buffer_load_dwordx4 v8, s[12:15], s17 offen offset:2048 lds
    buffer_load_dwordx4 v9, s[12:15], s17 offen offset:3072 lds
    s_add_u32 s78, s81, 2
    s_lshl_b32 s17, s78, 17
    s_add_u32 m0, s75, 65536
    s_nop 0
    buffer_load_dwordx4 v6, s[12:15], s17 offen offset:0 lds
    buffer_load_dwordx4 v7, s[12:15], s17 offen offset:1024 lds
    buffer_load_dwordx4 v8, s[12:15], s17 offen offset:2048 lds
    buffer_load_dwordx4 v9, s[12:15], s17 offen offset:3072 lds
    ds_read_b128 v[20:23], v102 offset:0
    ds_read_b128 v[24:27], v102 offset:1024
    ds_read_b128 v[28:31], v102 offset:2048
    ds_read_b128 v[32:35], v102 offset:3072
    ds_read_b128 v[36:39], v102 offset:4096
    ds_read_b128 v[40:43], v102 offset:5120
    ds_read_b128 v[44:47], v102 offset:6144
    ds_read_b128 v[48:51], v102 offset:7168
    ds_read_b128 v[52:55], v102 offset:8192
    ds_read_b128 v[56:59], v102 offset:9216
    ds_read_b128 v[60:63], v102 offset:10240
    ds_read_b128 v[64:67], v102 offset:11264
    ds_read_b128 v[68:71], v102 offset:12288
    ds_read_b128 v[72:75], v102 offset:13312
    ds_read_b128 v[76:79], v102 offset:14336
    ds_read_b128 v[80:83], v102 offset:15360
    s_waitcnt lgkmcnt(12)
    v_mfma_f32_16x16x32_bf16 v[184:187], v[20:23], v[104:107], 0
    v_mfma_f32_16x16x32_bf16 v[188:191], v[20:23], v[108:111], 0
    v_mfma_f32_16x16x32_bf16 v[184:187], v[24:27], v[112:115], v[184:187]
    v_mfma_f32_16x16x32_bf16 v[188:191], v[24:27], v[116:119], v[188:191]
    v_mfma_f32_16x16x32_bf16 v[184:187], v[28:31], v[120:123], v[184:187]
    v_mfma_f32_16x16x32_bf16 v[188:191], v[28:31], v[124:127], v[188:191]
    v_mfma_f32_16x16x32_bf16 v[184:187], v[32:35], v[128:131], v[184:187]
    v_mfma_f32_16x16x32_bf16 v[188:191], v[32:35], v[132:135], v[188:191]
    s_waitcnt lgkmcnt(8)
    v_mfma_f32_16x16x32_bf16 v[192:195], v[36:39], v[104:107], 0
    v_mfma_f32_16x16x32_bf16 v[196:199], v[36:39], v[108:111], 0
    v_mfma_f32_16x16x32_bf16 v[192:195], v[40:43], v[112:115], v[192:195]
    v_mfma_f32_16x16x32_bf16 v[196:199], v[40:43], v[116:119], v[196:199]
    v_mfma_f32_16x16x32_bf16 v[192:195], v[44:47], v[120:123], v[192:195]
    v_mfma_f32_16x16x32_bf16 v[196:199], v[44:47], v[124:127], v[196:199]
    v_mfma_f32_16x16x32_bf16 v[192:195], v[48:51], v[128:131], v[192:195]
    v_mfma_f32_16x16x32_bf16 v[196:199], v[48:51], v[132:135], v[196:199]
    s_waitcnt lgkmcnt(4)
    v_mfma_f32_16x16x32_bf16 v[200:203], v[52:55], v[104:107], 0
    v_mfma_f32_16x16x32_bf16 v[204:207], v[52:55], v[108:111], 0
    v_mfma_f32_16x16x32_bf16 v[200:203], v[56:59], v[112:115], v[200:203]
    v_mfma_f32_16x16x32_bf16 v[204:207], v[56:59], v[116:119], v[204:207]
    v_mfma_f32_16x16x32_bf16 v[200:203], v[60:63], v[120:123], v[200:203]
    v_mfma_f32_16x16x32_bf16 v[204:207], v[60:63], v[124:127], v[204:207]
    v_mfma_f32_16x16x32_bf16 v[200:203], v[64:67], v[128:131], v[200:203]
    v_mfma_f32_16x16x32_bf16 v[204:207], v[64:67], v[132:135], v[204:207]
    s_waitcnt lgkmcnt(0)
    v_mfma_f32_16x16x32_bf16 v[208:211], v[68:71], v[104:107], 0
    v_mfma_f32_16x16x32_bf16 v[212:215], v[68:71], v[108:111], 0
    v_mfma_f32_16x16x32_bf16 v[208:211], v[72:75], v[112:115], v[208:211]
    v_mfma_f32_16x16x32_bf16 v[212:215], v[72:75], v[116:119], v[212:215]
    v_mfma_f32_16x16x32_bf16 v[208:211], v[76:79], v[120:123], v[208:211]
    v_mfma_f32_16x16x32_bf16 v[212:215], v[76:79], v[124:127], v[212:215]
    v_mfma_f32_16x16x32_bf16 v[208:211], v[80:83], v[128:131], v[208:211]
    v_mfma_f32_16x16x32_bf16 v[212:215], v[80:83], v[132:135], v[212:215]
    v_mul_f32 v232, v184, v136
    v_mul_f32 v233, v188, v136
    v_mul_f32 v234, v185, v138
    v_mul_f32 v235, v189, v138
    v_mul_f32 v236, v186, v140
    v_mul_f32 v237, v190, v140
    v_mul_f32 v238, v187, v142
    v_mul_f32 v239, v191, v142
    v_fmac_f32 v232, v188, v137
    v_fma_f32 v233, -v184, v137, v233
    v_fmac_f32 v234, v189, v139
    v_fma_f32 v235, -v185, v139, v235
    v_fmac_f32 v236, v190, v141
    v_fma_f32 v237, -v186, v141, v237
    v_fmac_f32 v238, v191, v143
    v_fma_f32 v239, -v187, v143, v239
    v_cvt_pk_bf16_f32 v216, v232, v233
    v_cvt_pk_bf16_f32 v217, v234, v235
    v_cvt_pk_bf16_f32 v218, v236, v237
    v_cvt_pk_bf16_f32 v219, v238, v239
    v_mul_f32 v232, v192, v144
    v_mul_f32 v233, v196, v144
    v_mul_f32 v234, v193, v146
    v_mul_f32 v235, v197, v146
    v_mul_f32 v236, v194, v148
    v_mul_f32 v237, v198, v148
    v_mul_f32 v238, v195, v150
    v_mul_f32 v239, v199, v150
    v_fmac_f32 v232, v196, v145
    v_fma_f32 v233, -v192, v145, v233
    v_fmac_f32 v234, v197, v147
    v_fma_f32 v235, -v193, v147, v235
    v_fmac_f32 v236, v198, v149
    v_fma_f32 v237, -v194, v149, v237
    v_fmac_f32 v238, v199, v151
    v_fma_f32 v239, -v195, v151, v239
    v_cvt_pk_bf16_f32 v220, v232, v233
    v_cvt_pk_bf16_f32 v221, v234, v235
    v_cvt_pk_bf16_f32 v222, v236, v237
    v_cvt_pk_bf16_f32 v223, v238, v239
    v_mul_f32 v232, v200, v136
    v_mul_f32 v233, v204, v136
    v_mul_f32 v234, v201, v138
    v_mul_f32 v235, v205, v138
    v_mul_f32 v236, v202, v140
    v_mul_f32 v237, v206, v140
    v_mul_f32 v238, v203, v142
    v_mul_f32 v239, v207, v142
    v_fmac_f32 v232, v204, v137
    v_fma_f32 v233, -v200, v137, v233
    v_fmac_f32 v234, v205, v139
    v_fma_f32 v235, -v201, v139, v235
    v_fmac_f32 v236, v206, v141
    v_fma_f32 v237, -v202, v141, v237
    v_fmac_f32 v238, v207, v143
    v_fma_f32 v239, -v203, v143, v239
    v_cvt_pk_bf16_f32 v224, v232, v233
    v_cvt_pk_bf16_f32 v225, v234, v235
    v_cvt_pk_bf16_f32 v226, v236, v237
    v_cvt_pk_bf16_f32 v227, v238, v239
    v_mul_f32 v232, v208, v144
    v_mul_f32 v233, v212, v144
    v_mul_f32 v234, v209, v146
    v_mul_f32 v235, v213, v146
    v_mul_f32 v236, v210, v148
    v_mul_f32 v237, v214, v148
    v_mul_f32 v238, v211, v150
    v_mul_f32 v239, v215, v150
    v_fmac_f32 v232, v212, v145
    v_fma_f32 v233, -v208, v145, v233
    v_fmac_f32 v234, v213, v147
    v_fma_f32 v235, -v209, v147, v235
    v_fmac_f32 v236, v214, v149
    v_fma_f32 v237, -v210, v149, v237
    v_fmac_f32 v238, v215, v151
    v_fma_f32 v239, -v211, v151, v239
    v_cvt_pk_bf16_f32 v228, v232, v233
    v_cvt_pk_bf16_f32 v229, v234, v235
    v_cvt_pk_bf16_f32 v230, v236, v237
    v_cvt_pk_bf16_f32 v231, v238, v239
    v_mfma_f32_16x16x32_bf16 v[184:187], v[152:155], v[216:219], 0
    v_mfma_f32_16x16x32_bf16 v[188:191], v[160:163], v[216:219], 0
    v_mfma_f32_16x16x32_bf16 v[192:195], v[168:171], v[216:219], 0
    v_mfma_f32_16x16x32_bf16 v[196:199], v[176:179], v[216:219], 0
    v_mfma_f32_16x16x32_bf16 v[184:187], v[156:159], v[220:223], v[184:187]
    v_mfma_f32_16x16x32_bf16 v[188:191], v[164:167], v[220:223], v[188:191]
    v_mfma_f32_16x16x32_bf16 v[192:195], v[172:175], v[220:223], v[192:195]
    v_mfma_f32_16x16x32_bf16 v[196:199], v[180:183], v[220:223], v[196:199]
    v_mfma_f32_16x16x32_bf16 v[200:203], v[152:155], v[224:227], 0
    v_mfma_f32_16x16x32_bf16 v[204:207], v[160:163], v[224:227], 0
    v_mfma_f32_16x16x32_bf16 v[208:211], v[168:171], v[224:227], 0
    v_mfma_f32_16x16x32_bf16 v[212:215], v[176:179], v[224:227], 0
    v_mfma_f32_16x16x32_bf16 v[200:203], v[156:159], v[228:231], v[200:203]
    v_mfma_f32_16x16x32_bf16 v[204:207], v[164:167], v[228:231], v[204:207]
    v_mfma_f32_16x16x32_bf16 v[208:211], v[172:175], v[228:231], v[208:211]
    v_mfma_f32_16x16x32_bf16 v[212:215], v[180:183], v[228:231], v[212:215]
    s_cmp_lg_u32 s68, 0
    s_cbranch_scc1 Lns_3001
    s_add_u32 s6, s4, 4194304
    buffer_load_dwordx2 v[52:53], v101, s[56:59], s6 offen offset:0 sc1
    buffer_load_dwordx2 v[54:55], v101, s[56:59], s6 offen offset:1024 sc1
    s_add_u32 s22, s6, 8192
    buffer_load_dwordx2 v[56:57], v101, s[56:59], s22 offen offset:0 sc1
    buffer_load_dwordx2 v[58:59], v101, s[56:59], s22 offen offset:1024 sc1
    s_add_u32 s22, s6, 16384
    buffer_load_dwordx2 v[60:61], v101, s[56:59], s22 offen offset:0 sc1
    buffer_load_dwordx2 v[62:63], v101, s[56:59], s22 offen offset:1024 sc1
    s_add_u32 s22, s6, 24576
    buffer_load_dwordx2 v[64:65], v101, s[56:59], s22 offen offset:0 sc1
    buffer_load_dwordx2 v[66:67], v101, s[56:59], s22 offen offset:1024 sc1
    s_add_u32 s6, s6, 64
    buffer_load_dwordx2 v[68:69], v101, s[56:59], s6 offen offset:0 sc1
    buffer_load_dwordx2 v[70:71], v101, s[56:59], s6 offen offset:1024 sc1
    s_add_u32 s22, s6, 8192
    buffer_load_dwordx2 v[72:73], v101, s[56:59], s22 offen offset:0 sc1
    buffer_load_dwordx2 v[74:75], v101, s[56:59], s22 offen offset:1024 sc1
    s_add_u32 s22, s6, 16384
    buffer_load_dwordx2 v[76:77], v101, s[56:59], s22 offen offset:0 sc1
    buffer_load_dwordx2 v[78:79], v101, s[56:59], s22 offen offset:1024 sc1
    s_add_u32 s22, s6, 24576
    buffer_load_dwordx2 v[80:81], v101, s[56:59], s22 offen offset:0 sc1
    buffer_load_dwordx2 v[82:83], v101, s[56:59], s22 offen offset:1024 sc1
    v_xor_b32 v20, 0x80000000, v20
    v_xor_b32 v21, 0x80000000, v21
    v_xor_b32 v22, 0x80000000, v22
    v_xor_b32 v23, 0x80000000, v23
    v_xor_b32 v24, 0x80000000, v24
    v_xor_b32 v25, 0x80000000, v25
    v_xor_b32 v26, 0x80000000, v26
    v_xor_b32 v27, 0x80000000, v27
    v_xor_b32 v28, 0x80000000, v28
    v_xor_b32 v29, 0x80000000, v29
    v_xor_b32 v30, 0x80000000, v30
    v_xor_b32 v31, 0x80000000, v31
    v_xor_b32 v32, 0x80000000, v32
    v_xor_b32 v33, 0x80000000, v33
    v_xor_b32 v34, 0x80000000, v34
    v_xor_b32 v35, 0x80000000, v35
    v_xor_b32 v36, 0x80000000, v36
    v_xor_b32 v37, 0x80000000, v37
    v_xor_b32 v38, 0x80000000, v38
    v_xor_b32 v39, 0x80000000, v39
    v_xor_b32 v40, 0x80000000, v40
    v_xor_b32 v41, 0x80000000, v41
    v_xor_b32 v42, 0x80000000, v42
    v_xor_b32 v43, 0x80000000, v43
    v_xor_b32 v44, 0x80000000, v44
    v_xor_b32 v45, 0x80000000, v45
    v_xor_b32 v46, 0x80000000, v46
    v_xor_b32 v47, 0x80000000, v47
    v_xor_b32 v48, 0x80000000, v48
    v_xor_b32 v49, 0x80000000, v49
    v_xor_b32 v50, 0x80000000, v50
    v_xor_b32 v51, 0x80000000, v51
Lns_3001:
    s_cmp_lg_u32 s68, 0
    s_cbranch_scc1 Lns_3002
    s_waitcnt vmcnt(0)
    v_lshlrev_b32 v232, 16, v52
    v_and_b32 v233, 0xffff0000, v52
    v_mul_f32 v234, v232, v200
    v_mul_f32 v235, v232, v201
    v_fma_f32 v234, -v233, v201, v234
    v_fmac_f32 v235, v233, v200
    v_pk_add_f32 v[234:235], v[234:235], v[234:235]
    s_nop 0
    v_cvt_pk_bf16_f32 v52, v234, -v235
    v_lshlrev_b32 v236, 16, v54
    v_and_b32 v237, 0xffff0000, v54
    v_mul_f32 v238, v236, v202
    v_mul_f32 v239, v236, v203
    v_fma_f32 v238, -v237, v203, v238
    v_fmac_f32 v239, v237, v202
    v_pk_add_f32 v[238:239], v[238:239], v[238:239]
    s_nop 0
    v_cvt_pk_bf16_f32 v53, v238, -v239
    v_lshlrev_b32 v232, 16, v56
    v_and_b32 v233, 0xffff0000, v56
    v_mul_f32 v234, v232, v204
    v_mul_f32 v235, v232, v205
    v_fma_f32 v234, -v233, v205, v234
    v_fmac_f32 v235, v233, v204
    v_pk_add_f32 v[234:235], v[234:235], v[234:235]
    s_nop 0
    v_cvt_pk_bf16_f32 v54, v234, -v235
    v_lshlrev_b32 v236, 16, v58
    v_and_b32 v237, 0xffff0000, v58
    v_mul_f32 v238, v236, v206
    v_mul_f32 v239, v236, v207
    v_fma_f32 v238, -v237, v207, v238
    v_fmac_f32 v239, v237, v206
    v_pk_add_f32 v[238:239], v[238:239], v[238:239]
    s_nop 0
    v_cvt_pk_bf16_f32 v55, v238, -v239
    v_lshlrev_b32 v232, 16, v60
    v_and_b32 v233, 0xffff0000, v60
    v_mul_f32 v234, v232, v208
    v_mul_f32 v235, v232, v209
    v_fma_f32 v234, -v233, v209, v234
    v_fmac_f32 v235, v233, v208
    v_pk_add_f32 v[234:235], v[234:235], v[234:235]
    s_nop 0
    v_cvt_pk_bf16_f32 v56, v234, -v235
    v_lshlrev_b32 v236, 16, v62
    v_and_b32 v237, 0xffff0000, v62
    v_mul_f32 v238, v236, v210
    v_mul_f32 v239, v236, v211
    v_fma_f32 v238, -v237, v211, v238
    v_fmac_f32 v239, v237, v210
    v_pk_add_f32 v[238:239], v[238:239], v[238:239]
    s_nop 0
    v_cvt_pk_bf16_f32 v57, v238, -v239
    v_lshlrev_b32 v232, 16, v64
    v_and_b32 v233, 0xffff0000, v64
    v_mul_f32 v234, v232, v212
    v_mul_f32 v235, v232, v213
    v_fma_f32 v234, -v233, v213, v234
    v_fmac_f32 v235, v233, v212
    v_pk_add_f32 v[234:235], v[234:235], v[234:235]
    s_nop 0
    v_cvt_pk_bf16_f32 v58, v234, -v235
    v_lshlrev_b32 v236, 16, v66
    v_and_b32 v237, 0xffff0000, v66
    v_mul_f32 v238, v236, v214
    v_mul_f32 v239, v236, v215
    v_fma_f32 v238, -v237, v215, v238
    v_fmac_f32 v239, v237, v214
    v_pk_add_f32 v[238:239], v[238:239], v[238:239]
    s_nop 0
    v_cvt_pk_bf16_f32 v59, v238, -v239
Lns_3002:
    s_cmp_lg_u32 s68, 0
    s_cbranch_scc1 Lns_3003
    v_mfma_f32_16x16x32_bf16 v[200:203], v[20:23], v[104:107], 0
    v_mfma_f32_16x16x32_bf16 v[204:207], v[20:23], v[108:111], 0
    v_mfma_f32_16x16x32_bf16 v[200:203], v[24:27], v[112:115], v[200:203]
    v_mfma_f32_16x16x32_bf16 v[204:207], v[24:27], v[116:119], v[204:207]
    v_mfma_f32_16x16x32_bf16 v[200:203], v[28:31], v[120:123], v[200:203]
    v_mfma_f32_16x16x32_bf16 v[204:207], v[28:31], v[124:127], v[204:207]
    v_mfma_f32_16x16x32_bf16 v[200:203], v[32:35], v[128:131], v[200:203]
    v_mfma_f32_16x16x32_bf16 v[204:207], v[32:35], v[132:135], v[204:207]
    v_mfma_f32_16x16x32_bf16 v[208:211], v[36:39], v[104:107], 0
    v_mfma_f32_16x16x32_bf16 v[212:215], v[36:39], v[108:111], 0
    v_mfma_f32_16x16x32_bf16 v[208:211], v[40:43], v[112:115], v[208:211]
    v_mfma_f32_16x16x32_bf16 v[212:215], v[40:43], v[116:119], v[212:215]
    v_mfma_f32_16x16x32_bf16 v[208:211], v[44:47], v[120:123], v[208:211]
    v_mfma_f32_16x16x32_bf16 v[212:215], v[44:47], v[124:127], v[212:215]
    v_mfma_f32_16x16x32_bf16 v[208:211], v[48:51], v[128:131], v[208:211]
    v_mfma_f32_16x16x32_bf16 v[212:215], v[48:51], v[132:135], v[212:215]
    v_mul_f32 v232, v200, v136
    v_mul_f32 v233, v204, v136
    v_mul_f32 v234, v201, v138
    v_mul_f32 v235, v205, v138
    v_mul_f32 v236, v202, v140
    v_mul_f32 v237, v206, v140
    v_mul_f32 v238, v203, v142
    v_mul_f32 v239, v207, v142
    v_fmac_f32 v232, v204, v137
    v_fma_f32 v233, -v200, v137, v233
    v_fmac_f32 v234, v205, v139
    v_fma_f32 v235, -v201, v139, v235
    v_fmac_f32 v236, v206, v141
    v_fma_f32 v237, -v202, v141, v237
    v_fmac_f32 v238, v207, v143
    v_fma_f32 v239, -v203, v143, v239
    v_cvt_pk_bf16_f32 v216, v232, v233
    v_cvt_pk_bf16_f32 v217, v234, v235
    v_cvt_pk_bf16_f32 v218, v236, v237
    v_cvt_pk_bf16_f32 v219, v238, v239
    v_mul_f32 v232, v208, v144
    v_mul_f32 v233, v212, v144
    v_mul_f32 v234, v209, v146
    v_mul_f32 v235, v213, v146
    v_mul_f32 v236, v210, v148
    v_mul_f32 v237, v214, v148
    v_mul_f32 v238, v211, v150
    v_mul_f32 v239, v215, v150
    v_fmac_f32 v232, v212, v145
    v_fma_f32 v233, -v208, v145, v233
    v_fmac_f32 v234, v213, v147
    v_fma_f32 v235, -v209, v147, v235
    v_fmac_f32 v236, v214, v149
    v_fma_f32 v237, -v210, v149, v237
    v_fmac_f32 v238, v215, v151
    v_fma_f32 v239, -v211, v151, v239
    v_cvt_pk_bf16_f32 v220, v232, v233
    v_cvt_pk_bf16_f32 v221, v234, v235
    v_cvt_pk_bf16_f32 v222, v236, v237
    v_cvt_pk_bf16_f32 v223, v238, v239
    s_nop 1
    v_mfma_f32_16x16x32_bf16 v[200:203], v[152:155], v[216:219], 0
    v_mfma_f32_16x16x32_bf16 v[204:207], v[160:163], v[216:219], 0
    v_mfma_f32_16x16x32_bf16 v[208:211], v[168:171], v[216:219], 0
    v_mfma_f32_16x16x32_bf16 v[212:215], v[176:179], v[216:219], 0
    v_mfma_f32_16x16x32_bf16 v[200:203], v[156:159], v[220:223], v[200:203]
    v_mfma_f32_16x16x32_bf16 v[204:207], v[164:167], v[220:223], v[204:207]
    v_mfma_f32_16x16x32_bf16 v[208:211], v[172:175], v[220:223], v[208:211]
    v_mfma_f32_16x16x32_bf16 v[212:215], v[180:183], v[220:223], v[212:215]
    s_nop 7
Lns_3003:
    s_waitcnt vmcnt(0)
    s_cmp_lg_u32 s68, 0
    s_cbranch_scc1 Lns_3004
    v_lshlrev_b32 v232, 16, v84
    v_and_b32 v233, 0xffff0000, v84
    v_lshlrev_b32 v234, 16, v69
    v_and_b32 v235, 0xffff0000, v69
    v_pk_add_f32 v[236:237], v[232:233], v[234:235] neg_hi:[0,1]
    s_nop 0
    v_mul_f32 v236, 0.5, v236
    v_mul_f32 v237, 0.5, v237
    v_cvt_pk_bf16_f32 v84, v236, v237
    v_lshlrev_b32 v232, 16, v85
    v_and_b32 v233, 0xffff0000, v85
    v_lshlrev_b32 v234, 16, v68
    v_and_b32 v235, 0xffff0000, v68
    v_pk_add_f32 v[236:237], v[232:233], v[234:235] neg_hi:[0,1]
    s_nop 0
    v_mul_f32 v236, 0.5, v236
    v_mul_f32 v237, 0.5, v237
    v_cvt_pk_bf16_f32 v85, v236, v237
    v_lshlrev_b32 v232, 16, v86
    v_and_b32 v233, 0xffff0000, v86
    v_lshlrev_b32 v234, 16, v71
    v_and_b32 v235, 0xffff0000, v71
    v_pk_add_f32 v[236:237], v[232:233], v[234:235] neg_hi:[0,1]
    s_nop 0
    v_mul_f32 v236, 0.5, v236
    v_mul_f32 v237, 0.5, v237
    v_cvt_pk_bf16_f32 v86, v236, v237
    v_lshlrev_b32 v232, 16, v87
    v_and_b32 v233, 0xffff0000, v87
    v_lshlrev_b32 v234, 16, v70
    v_and_b32 v235, 0xffff0000, v70
    v_pk_add_f32 v[236:237], v[232:233], v[234:235] neg_hi:[0,1]
    s_nop 0
    v_mul_f32 v236, 0.5, v236
    v_mul_f32 v237, 0.5, v237
    v_cvt_pk_bf16_f32 v87, v236, v237
    v_lshlrev_b32 v232, 16, v88
    v_and_b32 v233, 0xffff0000, v88
    v_lshlrev_b32 v234, 16, v73
    v_and_b32 v235, 0xffff0000, v73
    v_pk_add_f32 v[236:237], v[232:233], v[234:235] neg_hi:[0,1]
    s_nop 0
    v_mul_f32 v236, 0.5, v236
    v_mul_f32 v237, 0.5, v237
    v_cvt_pk_bf16_f32 v88, v236, v237
    v_lshlrev_b32 v232, 16, v89
    v_and_b32 v233, 0xffff0000, v89
    v_lshlrev_b32 v234, 16, v72
    v_and_b32 v235, 0xffff0000, v72
    v_pk_add_f32 v[236:237], v[232:233], v[234:235] neg_hi:[0,1]
    s_nop 0
    v_mul_f32 v236, 0.5, v236
    v_mul_f32 v237, 0.5, v237
    v_cvt_pk_bf16_f32 v89, v236, v237
    v_lshlrev_b32 v232, 16, v90
    v_and_b32 v233, 0xffff0000, v90
    v_lshlrev_b32 v234, 16, v75
    v_and_b32 v235, 0xffff0000, v75
    v_pk_add_f32 v[236:237], v[232:233], v[234:235] neg_hi:[0,1]
    s_nop 0
    v_mul_f32 v236, 0.5, v236
    v_mul_f32 v237, 0.5, v237
    v_cvt_pk_bf16_f32 v90, v236, v237
    v_lshlrev_b32 v232, 16, v91
    v_and_b32 v233, 0xffff0000, v91
    v_lshlrev_b32 v234, 16, v74
    v_and_b32 v235, 0xffff0000, v74
    v_pk_add_f32 v[236:237], v[232:233], v[234:235] neg_hi:[0,1]
    s_nop 0
    v_mul_f32 v236, 0.5, v236
    v_mul_f32 v237, 0.5, v237
    v_cvt_pk_bf16_f32 v91, v236, v237
    s_nop 1
Lns_3004:
    s_cmp_lg_u32 s68, 0
    s_cbranch_scc1 Lns_3005
    v_lshlrev_b32 v232, 16, v92
    v_and_b32 v233, 0xffff0000, v92
    v_lshlrev_b32 v234, 16, v77
    v_and_b32 v235, 0xffff0000, v77
    v_pk_add_f32 v[236:237], v[232:233], v[234:235] neg_hi:[0,1]
    s_nop 0
    v_mul_f32 v236, 0.5, v236
    v_mul_f32 v237, 0.5, v237
    v_cvt_pk_bf16_f32 v92, v236, v237
    v_lshlrev_b32 v232, 16, v93
    v_and_b32 v233, 0xffff0000, v93
    v_lshlrev_b32 v234, 16, v76
    v_and_b32 v235, 0xffff0000, v76
    v_pk_add_f32 v[236:237], v[232:233], v[234:235] neg_hi:[0,1]
    s_nop 0
    v_mul_f32 v236, 0.5, v236
    v_mul_f32 v237, 0.5, v237
    v_cvt_pk_bf16_f32 v93, v236, v237
    v_lshlrev_b32 v232, 16, v94
    v_and_b32 v233, 0xffff0000, v94
    v_lshlrev_b32 v234, 16, v79
    v_and_b32 v235, 0xffff0000, v79
    v_pk_add_f32 v[236:237], v[232:233], v[234:235] neg_hi:[0,1]
    s_nop 0
    v_mul_f32 v236, 0.5, v236
    v_mul_f32 v237, 0.5, v237
    v_cvt_pk_bf16_f32 v94, v236, v237
    v_lshlrev_b32 v232, 16, v95
    v_and_b32 v233, 0xffff0000, v95
    v_lshlrev_b32 v234, 16, v78
    v_and_b32 v235, 0xffff0000, v78
    v_pk_add_f32 v[236:237], v[232:233], v[234:235] neg_hi:[0,1]
    s_nop 0
    v_mul_f32 v236, 0.5, v236
    v_mul_f32 v237, 0.5, v237
    v_cvt_pk_bf16_f32 v95, v236, v237
    v_lshlrev_b32 v232, 16, v96
    v_and_b32 v233, 0xffff0000, v96
    v_lshlrev_b32 v234, 16, v81
    v_and_b32 v235, 0xffff0000, v81
    v_pk_add_f32 v[236:237], v[232:233], v[234:235] neg_hi:[0,1]
    s_nop 0
    v_mul_f32 v236, 0.5, v236
    v_mul_f32 v237, 0.5, v237
    v_cvt_pk_bf16_f32 v96, v236, v237
    v_lshlrev_b32 v232, 16, v97
    v_and_b32 v233, 0xffff0000, v97
    v_lshlrev_b32 v234, 16, v80
    v_and_b32 v235, 0xffff0000, v80
    v_pk_add_f32 v[236:237], v[232:233], v[234:235] neg_hi:[0,1]
    s_nop 0
    v_mul_f32 v236, 0.5, v236
    v_mul_f32 v237, 0.5, v237
    v_cvt_pk_bf16_f32 v97, v236, v237
    v_lshlrev_b32 v232, 16, v98
    v_and_b32 v233, 0xffff0000, v98
    v_lshlrev_b32 v234, 16, v83
    v_and_b32 v235, 0xffff0000, v83
    v_pk_add_f32 v[236:237], v[232:233], v[234:235] neg_hi:[0,1]
    s_nop 0
    v_mul_f32 v236, 0.5, v236
    v_mul_f32 v237, 0.5, v237
    v_cvt_pk_bf16_f32 v98, v236, v237
    v_lshlrev_b32 v232, 16, v99
    v_and_b32 v233, 0xffff0000, v99
    v_lshlrev_b32 v234, 16, v82
    v_and_b32 v235, 0xffff0000, v82
    v_pk_add_f32 v[236:237], v[232:233], v[234:235] neg_hi:[0,1]
    s_nop 0
    v_mul_f32 v236, 0.5, v236
    v_mul_f32 v237, 0.5, v237
    v_cvt_pk_bf16_f32 v99, v236, v237
    s_nop 1
Lns_3005:
    v_mul_f32 v248, 0x3d000000, v18
    v_mul_f32 v249, 0.5, v19
    v_mul_f32 v249, v249, v248
    v_mov_b32 v233, v249
    v_fmamk_f32 v235, v248, 0x3f800000, v249
    v_fmamk_f32 v237, v248, 0x41000000, v249
    v_fmamk_f32 v239, v248, 0x41100000, v249
    v_cos_f32 v232, v233
    v_sin_f32 v233, v233
    v_cos_f32 v234, v235
    v_sin_f32 v235, v235
    v_cos_f32 v236, v237
    v_sin_f32 v237, v237
    v_cos_f32 v238, v239
    v_sin_f32 v239, v239
    v_cvt_pk_bf16_f32 v20, v232, v233
    v_cvt_pk_bf16_f32 v24, -v233, v232
    v_cvt_pk_bf16_f32 v21, v234, v235
    v_cvt_pk_bf16_f32 v25, -v235, v234
    v_cvt_pk_bf16_f32 v22, v236, v237
    v_cvt_pk_bf16_f32 v26, -v237, v236
    v_cvt_pk_bf16_f32 v23, v238, v239
    v_cvt_pk_bf16_f32 v27, -v239, v238
    v_xor_b32 v28, v251, v20
    v_xor_b32 v29, v251, v21
    v_xor_b32 v30, v251, v22
    v_xor_b32 v31, v251, v23
    v_xor_b32 v32, v251, v24
    v_xor_b32 v33, v251, v25
    v_xor_b32 v34, v251, v26
    v_xor_b32 v35, v251, v27
    v_cvt_pk_bf16_f32 v36, v232, v233
    v_cvt_pk_bf16_f32 v40, -v233, v232
    v_cvt_pk_bf16_f32 v37, -v234, -v235
    v_cvt_pk_bf16_f32 v41, v235, -v234
    v_cvt_pk_bf16_f32 v38, v236, v237
    v_cvt_pk_bf16_f32 v42, -v237, v236
    v_cvt_pk_bf16_f32 v39, -v238, -v239
    v_cvt_pk_bf16_f32 v43, v239, -v238
    v_xor_b32 v44, v251, v36
    v_xor_b32 v45, v251, v37
    v_xor_b32 v46, v251, v38
    v_xor_b32 v47, v251, v39
    v_xor_b32 v48, v251, v40
    v_xor_b32 v49, v251, v41
    v_xor_b32 v50, v251, v42
    v_xor_b32 v51, v251, v43
    v_cvt_f32_u32 v250, s5
    v_add_f32 v250, v250, v19
    v_add_f32 v248, 0x00000000, v18
    v_mul_f32 v248, 0x3a000000, v248
    v_mul_f32 v249, v250, v248
    v_mov_b32 v137, v249
    v_fmamk_f32 v139, v248, 0x3f800000, v249
    v_fmamk_f32 v141, v248, 0x40000000, v249
    v_fmamk_f32 v143, v248, 0x40400000, v249
    v_cos_f32 v136, v137
    v_sin_f32 v137, v137
    v_cos_f32 v138, v139
    v_sin_f32 v139, v139
    v_cos_f32 v140, v141
    v_sin_f32 v141, v141
    v_cos_f32 v142, v143
    v_sin_f32 v143, v143
    v_add_f32 v248, 0x41800000, v18
    v_mul_f32 v248, 0x3a000000, v248
    v_mul_f32 v249, v250, v248
    v_mov_b32 v145, v249
    v_fmamk_f32 v147, v248, 0x3f800000, v249
    v_fmamk_f32 v149, v248, 0x40000000, v249
    v_fmamk_f32 v151, v248, 0x40400000, v249
    v_cos_f32 v144, v145
    v_sin_f32 v145, v145
    v_cos_f32 v146, v147
    v_sin_f32 v147, v147
    v_cos_f32 v148, v149
    v_sin_f32 v149, v149
    v_cos_f32 v150, v151
    v_sin_f32 v151, v151
    v_mul_f32 v136, 0x35000000, v136
    v_mul_f32 v137, 0x35000000, v137
    v_mul_f32 v138, 0x35000000, v138
    v_mul_f32 v139, 0x35000000, v139
    v_mul_f32 v140, 0x35000000, v140
    v_mul_f32 v141, 0x35000000, v141
    v_mul_f32 v142, 0x35000000, v142
    v_mul_f32 v143, 0x35000000, v143
    v_mul_f32 v144, 0x35000000, v144
    v_mul_f32 v145, 0x35000000, v145
    v_mul_f32 v146, 0x35000000, v146
    v_mul_f32 v147, 0x35000000, v147
    v_mul_f32 v148, 0x35000000, v148
    v_mul_f32 v149, 0x35000000, v149
    v_mul_f32 v150, 0x35000000, v150
    v_mul_f32 v151, 0x35000000, v151
    v_cvt_f32_u32 v248, s68
    v_mul_f32 v248, 0x3a800000, v248
    v_sin_f32 v60, v248
    v_cos_f32 v62, v248
    v_sin_f32 v61, v248
    v_cos_f32 v63, v248
    v_lshlrev_b32 v64, 16, v84
    v_and_b32 v65, 0xffff0000, v84
    v_lshlrev_b32 v66, 16, v85
    v_and_b32 v67, 0xffff0000, v85
    v_pk_add_f32 v[68:69], v[64:65], v[66:67] neg_hi:[0,1]
    v_pk_add_f32 v[70:71], v[64:65], v[66:67] neg_lo:[0,1]
    s_nop 0
    v_pk_fma_f32 v[72:73], v[70:71], v[60:61], v[68:69] neg_lo:[1,0,0] neg_hi:[1,0,0]
    v_pk_fma_f32 v[74:75], v[70:71], v[60:61], v[68:69]
    v_pk_mul_f32 v[76:77], v[70:71], v[62:63]
    v_mul_f32 v78, v72, v184
    v_mul_f32 v79, v72, v185
    v_mul_f32 v80, v74, v200
    v_mul_f32 v81, v74, v201
    v_fma_f32 v78, -v73, v185, v78
    v_fmac_f32 v79, v73, v184
    v_fma_f32 v80, -v75, v201, v80
    v_fmac_f32 v81, v75, v200
    v_fma_f32 v78, -v76, v201, v78
    v_fmac_f32 v79, v76, v200
    v_fmac_f32 v80, v76, v185
    v_fma_f32 v81, -v76, v184, v81
    v_fma_f32 v78, -v77, v200, v78
    v_fma_f32 v79, -v77, v201, v79
    v_fmac_f32 v80, v77, v184
    v_fmac_f32 v81, v77, v185
    v_cvt_pk_bf16_f32 v216, v78, -v79
    v_cvt_pk_bf16_f32 v224, v80, -v81
    v_lshlrev_b32 v64, 16, v86
    v_and_b32 v65, 0xffff0000, v86
    v_lshlrev_b32 v66, 16, v87
    v_and_b32 v67, 0xffff0000, v87
    v_pk_add_f32 v[68:69], v[64:65], v[66:67] neg_hi:[0,1]
    v_pk_add_f32 v[70:71], v[64:65], v[66:67] neg_lo:[0,1]
    s_nop 0
    v_pk_fma_f32 v[72:73], v[70:71], v[60:61], v[68:69] neg_lo:[1,0,0] neg_hi:[1,0,0]
    v_pk_fma_f32 v[74:75], v[70:71], v[60:61], v[68:69]
    v_pk_mul_f32 v[76:77], v[70:71], v[62:63]
    v_mul_f32 v78, v72, v186
    v_mul_f32 v79, v72, v187
    v_mul_f32 v80, v74, v202
    v_mul_f32 v81, v74, v203
    v_fma_f32 v78, -v73, v187, v78
    v_fmac_f32 v79, v73, v186
    v_fma_f32 v80, -v75, v203, v80
    v_fmac_f32 v81, v75, v202
    v_fma_f32 v78, -v76, v203, v78
    v_fmac_f32 v79, v76, v202
    v_fmac_f32 v80, v76, v187
    v_fma_f32 v81, -v76, v186, v81
    v_fma_f32 v78, -v77, v202, v78
    v_fma_f32 v79, -v77, v203, v79
    v_fmac_f32 v80, v77, v186
    v_fmac_f32 v81, v77, v187
    v_cvt_pk_bf16_f32 v217, v78, -v79
    v_cvt_pk_bf16_f32 v225, v80, -v81
    v_lshlrev_b32 v64, 16, v88
    v_and_b32 v65, 0xffff0000, v88
    v_lshlrev_b32 v66, 16, v89
    v_and_b32 v67, 0xffff0000, v89
    v_pk_add_f32 v[68:69], v[64:65], v[66:67] neg_hi:[0,1]
    v_pk_add_f32 v[70:71], v[64:65], v[66:67] neg_lo:[0,1]
    s_nop 0
    v_pk_fma_f32 v[72:73], v[70:71], v[60:61], v[68:69] neg_lo:[1,0,0] neg_hi:[1,0,0]
    v_pk_fma_f32 v[74:75], v[70:71], v[60:61], v[68:69]
    v_pk_mul_f32 v[76:77], v[70:71], v[62:63]
    v_mul_f32 v78, v72, v188
    v_mul_f32 v79, v72, v189
    v_mul_f32 v80, v74, v204
    v_mul_f32 v81, v74, v205
    v_fma_f32 v78, -v73, v189, v78
    v_fmac_f32 v79, v73, v188
    v_fma_f32 v80, -v75, v205, v80
    v_fmac_f32 v81, v75, v204
    v_fma_f32 v78, -v76, v205, v78
    v_fmac_f32 v79, v76, v204
    v_fmac_f32 v80, v76, v189
    v_fma_f32 v81, -v76, v188, v81
    v_fma_f32 v78, -v77, v204, v78
    v_fma_f32 v79, -v77, v205, v79
    v_fmac_f32 v80, v77, v188
    v_fmac_f32 v81, v77, v189
    v_cvt_pk_bf16_f32 v218, v78, -v79
    v_cvt_pk_bf16_f32 v226, v80, -v81
    v_lshlrev_b32 v64, 16, v90
    v_and_b32 v65, 0xffff0000, v90
    v_lshlrev_b32 v66, 16, v91
    v_and_b32 v67, 0xffff0000, v91
    v_pk_add_f32 v[68:69], v[64:65], v[66:67] neg_hi:[0,1]
    v_pk_add_f32 v[70:71], v[64:65], v[66:67] neg_lo:[0,1]
    s_nop 0
    v_pk_fma_f32 v[72:73], v[70:71], v[60:61], v[68:69] neg_lo:[1,0,0] neg_hi:[1,0,0]
    v_pk_fma_f32 v[74:75], v[70:71], v[60:61], v[68:69]
    v_pk_mul_f32 v[76:77], v[70:71], v[62:63]
    v_mul_f32 v78, v72, v190
    v_mul_f32 v79, v72, v191
    v_mul_f32 v80, v74, v206
    v_mul_f32 v81, v74, v207
    v_fma_f32 v78, -v73, v191, v78
    v_fmac_f32 v79, v73, v190
    v_fma_f32 v80, -v75, v207, v80
    v_fmac_f32 v81, v75, v206
    v_fma_f32 v78, -v76, v207, v78
    v_fmac_f32 v79, v76, v206
    v_fmac_f32 v80, v76, v191
    v_fma_f32 v81, -v76, v190, v81
    v_fma_f32 v78, -v77, v206, v78
    v_fma_f32 v79, -v77, v207, v79
    v_fmac_f32 v80, v77, v190
    v_fmac_f32 v81, v77, v191
    v_cvt_pk_bf16_f32 v219, v78, -v79
    v_cvt_pk_bf16_f32 v227, v80, -v81
    v_lshlrev_b32 v64, 16, v92
    v_and_b32 v65, 0xffff0000, v92
    v_lshlrev_b32 v66, 16, v93
    v_and_b32 v67, 0xffff0000, v93
    v_pk_add_f32 v[68:69], v[64:65], v[66:67] neg_hi:[0,1]
    v_pk_add_f32 v[70:71], v[64:65], v[66:67] neg_lo:[0,1]
    s_nop 0
    v_pk_fma_f32 v[72:73], v[70:71], v[60:61], v[68:69] neg_lo:[1,0,0] neg_hi:[1,0,0]
    v_pk_fma_f32 v[74:75], v[70:71], v[60:61], v[68:69]
    v_pk_mul_f32 v[76:77], v[70:71], v[62:63]
    v_mul_f32 v78, v72, v192
    v_mul_f32 v79, v72, v193
    v_mul_f32 v80, v74, v208
    v_mul_f32 v81, v74, v209
    v_fma_f32 v78, -v73, v193, v78
    v_fmac_f32 v79, v73, v192
    v_fma_f32 v80, -v75, v209, v80
    v_fmac_f32 v81, v75, v208
    v_fma_f32 v78, -v76, v209, v78
    v_fmac_f32 v79, v76, v208
    v_fmac_f32 v80, v76, v193
    v_fma_f32 v81, -v76, v192, v81
    v_fma_f32 v78, -v77, v208, v78
    v_fma_f32 v79, -v77, v209, v79
    v_fmac_f32 v80, v77, v192
    v_fmac_f32 v81, v77, v193
    v_cvt_pk_bf16_f32 v220, v78, -v79
    v_cvt_pk_bf16_f32 v228, v80, -v81
    v_lshlrev_b32 v64, 16, v94
    v_and_b32 v65, 0xffff0000, v94
    v_lshlrev_b32 v66, 16, v95
    v_and_b32 v67, 0xffff0000, v95
    v_pk_add_f32 v[68:69], v[64:65], v[66:67] neg_hi:[0,1]
    v_pk_add_f32 v[70:71], v[64:65], v[66:67] neg_lo:[0,1]
    s_nop 0
    v_pk_fma_f32 v[72:73], v[70:71], v[60:61], v[68:69] neg_lo:[1,0,0] neg_hi:[1,0,0]
    v_pk_fma_f32 v[74:75], v[70:71], v[60:61], v[68:69]
    v_pk_mul_f32 v[76:77], v[70:71], v[62:63]
    v_mul_f32 v78, v72, v194
    v_mul_f32 v79, v72, v195
    v_mul_f32 v80, v74, v210
    v_mul_f32 v81, v74, v211
    v_fma_f32 v78, -v73, v195, v78
    v_fmac_f32 v79, v73, v194
    v_fma_f32 v80, -v75, v211, v80
    v_fmac_f32 v81, v75, v210
    v_fma_f32 v78, -v76, v211, v78
    v_fmac_f32 v79, v76, v210
    v_fmac_f32 v80, v76, v195
    v_fma_f32 v81, -v76, v194, v81
    v_fma_f32 v78, -v77, v210, v78
    v_fma_f32 v79, -v77, v211, v79
    v_fmac_f32 v80, v77, v194
    v_fmac_f32 v81, v77, v195
    v_cvt_pk_bf16_f32 v221, v78, -v79
    v_cvt_pk_bf16_f32 v229, v80, -v81
    v_lshlrev_b32 v64, 16, v96
    v_and_b32 v65, 0xffff0000, v96
    v_lshlrev_b32 v66, 16, v97
    v_and_b32 v67, 0xffff0000, v97
    v_pk_add_f32 v[68:69], v[64:65], v[66:67] neg_hi:[0,1]
    v_pk_add_f32 v[70:71], v[64:65], v[66:67] neg_lo:[0,1]
    s_nop 0
    v_pk_fma_f32 v[72:73], v[70:71], v[60:61], v[68:69] neg_lo:[1,0,0] neg_hi:[1,0,0]
    v_pk_fma_f32 v[74:75], v[70:71], v[60:61], v[68:69]
    v_pk_mul_f32 v[76:77], v[70:71], v[62:63]
    v_mul_f32 v78, v72, v196
    v_mul_f32 v79, v72, v197
    v_mul_f32 v80, v74, v212
    v_mul_f32 v81, v74, v213
    v_fma_f32 v78, -v73, v197, v78
    v_fmac_f32 v79, v73, v196
    v_fma_f32 v80, -v75, v213, v80
    v_fmac_f32 v81, v75, v212
    v_fma_f32 v78, -v76, v213, v78
    v_fmac_f32 v79, v76, v212
    v_fmac_f32 v80, v76, v197
    v_fma_f32 v81, -v76, v196, v81
    v_fma_f32 v78, -v77, v212, v78
    v_fma_f32 v79, -v77, v213, v79
    v_fmac_f32 v80, v77, v196
    v_fmac_f32 v81, v77, v197
    v_cvt_pk_bf16_f32 v222, v78, -v79
    v_cvt_pk_bf16_f32 v230, v80, -v81
    v_lshlrev_b32 v64, 16, v98
    v_and_b32 v65, 0xffff0000, v98
    v_lshlrev_b32 v66, 16, v99
    v_and_b32 v67, 0xffff0000, v99
    v_pk_add_f32 v[68:69], v[64:65], v[66:67] neg_hi:[0,1]
    v_pk_add_f32 v[70:71], v[64:65], v[66:67] neg_lo:[0,1]
    s_nop 0
    v_pk_fma_f32 v[72:73], v[70:71], v[60:61], v[68:69] neg_lo:[1,0,0] neg_hi:[1,0,0]
    v_pk_fma_f32 v[74:75], v[70:71], v[60:61], v[68:69]
    v_pk_mul_f32 v[76:77], v[70:71], v[62:63]
    v_mul_f32 v78, v72, v198
    v_mul_f32 v79, v72, v199
    v_mul_f32 v80, v74, v214
    v_mul_f32 v81, v74, v215
    v_fma_f32 v78, -v73, v199, v78
    v_fmac_f32 v79, v73, v198
    v_fma_f32 v80, -v75, v215, v80
    v_fmac_f32 v81, v75, v214
    v_fma_f32 v78, -v76, v215, v78
    v_fmac_f32 v79, v76, v214
    v_fmac_f32 v80, v76, v199
    v_fma_f32 v81, -v76, v198, v81
    v_fma_f32 v78, -v77, v214, v78
    v_fma_f32 v79, -v77, v215, v79
    v_fmac_f32 v80, v77, v198
    v_fmac_f32 v81, v77, v199
    v_cvt_pk_bf16_f32 v223, v78, -v79
    v_cvt_pk_bf16_f32 v231, v80, -v81
    s_cmp_lg_u32 s68, 0
    s_cbranch_scc1 Lns_3006
    v_mov_b32 v224, v52
    v_mov_b32 v225, v53
    v_mov_b32 v226, v54
    v_mov_b32 v227, v55
    v_mov_b32 v228, v56
    v_mov_b32 v229, v57
    v_mov_b32 v230, v58
    v_mov_b32 v231, v59
    s_nop 1
Lns_3006:
    v_mfma_f32_16x16x32_bf16 v[184:187], v[216:219], v[20:23], 0
    v_mfma_f32_16x16x32_bf16 v[188:191], v[216:219], v[24:27], 0
    v_mfma_f32_16x16x32_bf16 v[184:187], v[220:223], v[28:31], v[184:187]
    v_mfma_f32_16x16x32_bf16 v[188:191], v[220:223], v[32:35], v[188:191]
    v_mfma_f32_16x16x32_bf16 v[192:195], v[216:219], v[36:39], 0
    v_mfma_f32_16x16x32_bf16 v[196:199], v[216:219], v[40:43], 0
    v_mfma_f32_16x16x32_bf16 v[192:195], v[220:223], v[44:47], v[192:195]
    v_mfma_f32_16x16x32_bf16 v[196:199], v[220:223], v[48:51], v[196:199]
    v_mfma_f32_16x16x32_bf16 v[200:203], v[224:227], v[20:23], 0
    v_mfma_f32_16x16x32_bf16 v[204:207], v[224:227], v[24:27], 0
    v_mfma_f32_16x16x32_bf16 v[200:203], v[228:231], v[28:31], v[200:203]
    v_mfma_f32_16x16x32_bf16 v[204:207], v[228:231], v[32:35], v[204:207]
    v_mfma_f32_16x16x32_bf16 v[208:211], v[224:227], v[36:39], 0
    v_mfma_f32_16x16x32_bf16 v[212:215], v[224:227], v[40:43], 0
    v_mfma_f32_16x16x32_bf16 v[208:211], v[228:231], v[44:47], v[208:211]
    v_mfma_f32_16x16x32_bf16 v[212:215], v[228:231], v[48:51], v[212:215]
    s_lshl_b32 s6, s28, 2
    v_add_u32 v248, s6, v17
    v_xor_b32 v248, v248, v16
    v_lshlrev_b32 v248, 4, v248
    v_lshl_add_u32 v248, v16, 8, v248
    v_add_u32 v248, 135168, v248
    s_waitcnt lgkmcnt(0)
    v_mov_b32 v13, 151596
    v_mov_b32 v14, 1
    s_mov_b64 exec, 1
    ds_add_u32 v13, v14
Lcb_29:
    ds_read_b32 v14, v13
    s_waitcnt lgkmcnt(0)
    v_readfirstlane_b32 s7, v14
    s_nop 0
    s_cmp_ge_u32 s7, 4
    s_cbranch_scc0 Lcb_29
    s_mov_b64 exec, -1
    v_mul_f32 v232, v184, v136
    v_mul_f32 v233, v188, v136
    v_mul_f32 v234, v185, v138
    v_mul_f32 v235, v189, v138
    v_mul_f32 v236, v186, v140
    v_mul_f32 v237, v190, v140
    v_mul_f32 v238, v187, v142
    v_mul_f32 v239, v191, v142
    v_fmac_f32 v232, v188, v137
    v_fma_f32 v233, -v184, v137, v233
    v_fmac_f32 v234, v189, v139
    v_fma_f32 v235, -v185, v139, v235
    v_fmac_f32 v236, v190, v141
    v_fma_f32 v237, -v186, v141, v237
    v_fmac_f32 v238, v191, v143
    v_fma_f32 v239, -v187, v143, v239
    v_cvt_pk_bf16_f32 v152, v232, v233
    v_cvt_pk_bf16_f32 v153, v234, v235
    v_cvt_pk_bf16_f32 v154, v236, v237
    v_cvt_pk_bf16_f32 v155, v238, v239
    ds_write_b128 v248, v[152:155] offset:0
    v_mul_f32 v232, v192, v144
    v_mul_f32 v233, v196, v144
    v_mul_f32 v234, v193, v146
    v_mul_f32 v235, v197, v146
    v_mul_f32 v236, v194, v148
    v_mul_f32 v237, v198, v148
    v_mul_f32 v238, v195, v150
    v_mul_f32 v239, v199, v150
    v_fmac_f32 v232, v196, v145
    v_fma_f32 v233, -v192, v145, v233
    v_fmac_f32 v234, v197, v147
    v_fma_f32 v235, -v193, v147, v235
    v_fmac_f32 v236, v198, v149
    v_fma_f32 v237, -v194, v149, v237
    v_fmac_f32 v238, v199, v151
    v_fma_f32 v239, -v195, v151, v239
    v_cvt_pk_bf16_f32 v156, v232, v233
    v_cvt_pk_bf16_f32 v157, v234, v235
    v_cvt_pk_bf16_f32 v158, v236, v237
    v_cvt_pk_bf16_f32 v159, v238, v239
    ds_write_b128 v248, v[156:159] offset:4096
    v_mul_f32 v232, v200, v136
    v_mul_f32 v233, v204, v136
    v_mul_f32 v234, v201, v138
    v_mul_f32 v235, v205, v138
    v_mul_f32 v236, v202, v140
    v_mul_f32 v237, v206, v140
    v_mul_f32 v238, v203, v142
    v_mul_f32 v239, v207, v142
    v_fmac_f32 v232, v204, v137
    v_fma_f32 v233, -v200, v137, v233
    v_fmac_f32 v234, v205, v139
    v_fma_f32 v235, -v201, v139, v235
    v_fmac_f32 v236, v206, v141
    v_fma_f32 v237, -v202, v141, v237
    v_fmac_f32 v238, v207, v143
    v_fma_f32 v239, -v203, v143, v239
    v_cvt_pk_bf16_f32 v160, v232, v233
    v_cvt_pk_bf16_f32 v161, v234, v235
    v_cvt_pk_bf16_f32 v162, v236, v237
    v_cvt_pk_bf16_f32 v163, v238, v239
    ds_write_b128 v248, v[160:163] offset:8192
    v_mul_f32 v232, v208, v144
    v_mul_f32 v233, v212, v144
    v_mul_f32 v234, v209, v146
    v_mul_f32 v235, v213, v146
    v_mul_f32 v236, v210, v148
    v_mul_f32 v237, v214, v148
    v_mul_f32 v238, v211, v150
    v_mul_f32 v239, v215, v150
    v_fmac_f32 v232, v212, v145
    v_fma_f32 v233, -v208, v145, v233
    v_fmac_f32 v234, v213, v147
    v_fma_f32 v235, -v209, v147, v235
    v_fmac_f32 v236, v214, v149
    v_fma_f32 v237, -v210, v149, v237
    v_fmac_f32 v238, v215, v151
    v_fma_f32 v239, -v211, v151, v239
    v_cvt_pk_bf16_f32 v164, v232, v233
    v_cvt_pk_bf16_f32 v165, v234, v235
    v_cvt_pk_bf16_f32 v166, v236, v237
    v_cvt_pk_bf16_f32 v167, v238, v239
    ds_write_b128 v248, v[164:167] offset:12288
    v_xor_b32 v232, v17, v16
    v_lshlrev_b32 v232, 4, v232
    v_lshl_add_u32 v232, v16, 8, v232
    v_add_u32 v232, 135168, v232
    v_xor_b32 v233, 64, v232
    v_xor_b32 v234, 128, v232
    v_xor_b32 v235, 192, v232
    s_waitcnt lgkmcnt(0)
    v_mov_b32 v13, 151596
    v_mov_b32 v14, 1
    s_mov_b64 exec, 1
    ds_add_u32 v13, v14
Lcb_30:
    ds_read_b32 v14, v13
    s_waitcnt lgkmcnt(0)
    v_readfirstlane_b32 s7, v14
    s_nop 0
    s_cmp_ge_u32 s7, 8
    s_cbranch_scc0 Lcb_30
    s_mov_b64 exec, -1
    v_mov_b32 v13, 151556
    ds_read_b32 v14, v13
    s_waitcnt lgkmcnt(0)
    v_readfirstlane_b32 s23, v14
    s_nop 0
    s_cmp_ge_u32 s23, 4
    s_cbranch_scc0 Lne_31
    s_add_u32 s78, s81, 0
    s_lshl_b32 s16, s78, 11
    s_add_u32 m0, s74, 0
    s_nop 0
    buffer_load_dwordx4 v2, s[8:11], s16 offen offset:0 lds
    buffer_load_dwordx4 v3, s[8:11], s16 offen offset:1024 lds
    buffer_load_dwordx4 v4, s[8:11], s16 offen offset:2048 lds
    buffer_load_dwordx4 v5, s[8:11], s16 offen offset:3072 lds
    s_add_u32 s78, s81, 1
    s_lshl_b32 s16, s78, 11
    s_add_u32 m0, s74, 32768
    s_nop 0
    buffer_load_dwordx4 v2, s[8:11], s16 offen offset:0 lds
    buffer_load_dwordx4 v3, s[8:11], s16 offen offset:1024 lds
    buffer_load_dwordx4 v4, s[8:11], s16 offen offset:2048 lds
    buffer_load_dwordx4 v5, s[8:11], s16 offen offset:3072 lds
    s_add_u32 s78, s81, 2
    s_lshl_b32 s16, s78, 11
    s_add_u32 m0, s74, 65536
    s_nop 0
    buffer_load_dwordx4 v2, s[8:11], s16 offen offset:0 lds
    buffer_load_dwordx4 v3, s[8:11], s16 offen offset:1024 lds
    buffer_load_dwordx4 v4, s[8:11], s16 offen offset:2048 lds
    buffer_load_dwordx4 v5, s[8:11], s16 offen offset:3072 lds
Lne_31:
    ds_read_b128 v[20:23], v232 offset:0
    ds_read_b128 v[24:27], v233 offset:0
    ds_read_b128 v[28:31], v234 offset:0
    ds_read_b128 v[32:35], v235 offset:0
    ds_read_b128 v[36:39], v232 offset:4096
    ds_read_b128 v[40:43], v233 offset:4096
    ds_read_b128 v[44:47], v234 offset:4096
    ds_read_b128 v[48:51], v235 offset:4096
    ds_read_b128 v[52:55], v232 offset:8192
    ds_read_b128 v[56:59], v233 offset:8192
    ds_read_b128 v[60:63], v234 offset:8192
    ds_read_b128 v[64:67], v235 offset:8192
    ds_read_b128 v[68:71], v232 offset:12288
    ds_read_b128 v[72:75], v233 offset:12288
    ds_read_b128 v[76:79], v234 offset:12288
    ds_read_b128 v[80:83], v235 offset:12288
    v_lshlrev_b32 v100, 4, v1
    s_lshl_b32 s4, s28, 12
    s_lshl_b32 s3, s68, 14
    s_add_u32 s4, s4, s3
    s_add_u32 s4, s4, 27262976
    s_waitcnt lgkmcnt(12)
    v_mfma_f32_16x16x32_bf16 v[184:187], v[20:23], v[104:107], 0
    v_mfma_f32_16x16x32_bf16 v[188:191], v[20:23], v[108:111], 0
    v_mfma_f32_16x16x32_bf16 v[184:187], v[24:27], v[112:115], v[184:187]
    v_mfma_f32_16x16x32_bf16 v[188:191], v[24:27], v[116:119], v[188:191]
    v_mfma_f32_16x16x32_bf16 v[184:187], v[28:31], v[120:123], v[184:187]
    v_mfma_f32_16x16x32_bf16 v[188:191], v[28:31], v[124:127], v[188:191]
    v_mfma_f32_16x16x32_bf16 v[184:187], v[32:35], v[128:131], v[184:187]
    v_mfma_f32_16x16x32_bf16 v[188:191], v[32:35], v[132:135], v[188:191]
    s_waitcnt lgkmcnt(8)
    v_mfma_f32_16x16x32_bf16 v[192:195], v[36:39], v[104:107], 0
    v_mfma_f32_16x16x32_bf16 v[196:199], v[36:39], v[108:111], 0
    v_mfma_f32_16x16x32_bf16 v[192:195], v[40:43], v[112:115], v[192:195]
    v_mfma_f32_16x16x32_bf16 v[196:199], v[40:43], v[116:119], v[196:199]
    v_mfma_f32_16x16x32_bf16 v[192:195], v[44:47], v[120:123], v[192:195]
    v_mfma_f32_16x16x32_bf16 v[196:199], v[44:47], v[124:127], v[196:199]
    v_mfma_f32_16x16x32_bf16 v[192:195], v[48:51], v[128:131], v[192:195]
    v_mfma_f32_16x16x32_bf16 v[196:199], v[48:51], v[132:135], v[196:199]
    s_waitcnt lgkmcnt(4)
    v_mfma_f32_16x16x32_bf16 v[200:203], v[52:55], v[104:107], 0
    v_mfma_f32_16x16x32_bf16 v[204:207], v[52:55], v[108:111], 0
    v_mfma_f32_16x16x32_bf16 v[200:203], v[56:59], v[112:115], v[200:203]
    v_mfma_f32_16x16x32_bf16 v[204:207], v[56:59], v[116:119], v[204:207]
    v_mfma_f32_16x16x32_bf16 v[200:203], v[60:63], v[120:123], v[200:203]
    v_mfma_f32_16x16x32_bf16 v[204:207], v[60:63], v[124:127], v[204:207]
    v_mfma_f32_16x16x32_bf16 v[200:203], v[64:67], v[128:131], v[200:203]
    v_mfma_f32_16x16x32_bf16 v[204:207], v[64:67], v[132:135], v[204:207]
    s_waitcnt lgkmcnt(0)
    v_mfma_f32_16x16x32_bf16 v[208:211], v[68:71], v[104:107], 0
    v_mfma_f32_16x16x32_bf16 v[212:215], v[68:71], v[108:111], 0
    v_mfma_f32_16x16x32_bf16 v[208:211], v[72:75], v[112:115], v[208:211]
    v_mfma_f32_16x16x32_bf16 v[212:215], v[72:75], v[116:119], v[212:215]
    v_mfma_f32_16x16x32_bf16 v[208:211], v[76:79], v[120:123], v[208:211]
    v_mfma_f32_16x16x32_bf16 v[212:215], v[76:79], v[124:127], v[212:215]
    v_mfma_f32_16x16x32_bf16 v[208:211], v[80:83], v[128:131], v[208:211]
    v_mfma_f32_16x16x32_bf16 v[212:215], v[80:83], v[132:135], v[212:215]
    v_cvt_pk_bf16_f32 v152, v184, v188
    v_cvt_pk_bf16_f32 v153, v185, v189
    v_cvt_pk_bf16_f32 v154, v186, v190
    v_cvt_pk_bf16_f32 v155, v187, v191
    buffer_store_dwordx4 v[152:155], v100, s[56:59], s4 offen offset:0 sc1
    v_cvt_pk_bf16_f32 v156, v192, v196
    v_cvt_pk_bf16_f32 v157, v193, v197
    v_cvt_pk_bf16_f32 v158, v194, v198
    v_cvt_pk_bf16_f32 v159, v195, v199
    buffer_store_dwordx4 v[156:159], v100, s[56:59], s4 offen offset:2048 sc1
    v_cvt_pk_bf16_f32 v160, v200, v204
    v_cvt_pk_bf16_f32 v161, v201, v205
    v_cvt_pk_bf16_f32 v162, v202, v206
    v_cvt_pk_bf16_f32 v163, v203, v207
    buffer_store_dwordx4 v[160:163], v100, s[56:59], s4 offen offset:1024 sc1
    v_cvt_pk_bf16_f32 v164, v208, v212
    v_cvt_pk_bf16_f32 v165, v209, v213
    v_cvt_pk_bf16_f32 v166, v210, v214
    v_cvt_pk_bf16_f32 v167, v211, v215
    buffer_store_dwordx4 v[164:167], v100, s[56:59], s4 offen offset:3072 sc1
    v_and_b32 v12, 7, v1
    v_lshlrev_b32 v12, 2, v12
    s_cmp_ge_u32 s23, 4
    s_cbranch_scc1 Lea_32
    v_mov_b32 v13, 151556
Lpl_34:
    ds_read_b32 v14, v13
    s_waitcnt lgkmcnt(0)
    v_readfirstlane_b32 s78, v14
    s_nop 0
    s_cmp_ge_u32 s78, 4
    s_cbranch_scc0 Lpl_34
    s_add_u32 s78, s81, 0
    s_lshl_b32 s16, s78, 11
    s_add_u32 m0, s74, 0
    s_nop 0
    buffer_load_dwordx4 v2, s[8:11], s16 offen offset:0 lds
    buffer_load_dwordx4 v3, s[8:11], s16 offen offset:1024 lds
    buffer_load_dwordx4 v4, s[8:11], s16 offen offset:2048 lds
    buffer_load_dwordx4 v5, s[8:11], s16 offen offset:3072 lds
    s_add_u32 s78, s81, 1
    s_lshl_b32 s16, s78, 11
    s_add_u32 m0, s74, 32768
    s_nop 0
    buffer_load_dwordx4 v2, s[8:11], s16 offen offset:0 lds
    buffer_load_dwordx4 v3, s[8:11], s16 offen offset:1024 lds
    buffer_load_dwordx4 v4, s[8:11], s16 offen offset:2048 lds
    buffer_load_dwordx4 v5, s[8:11], s16 offen offset:3072 lds
    s_add_u32 s78, s81, 2
    s_lshl_b32 s16, s78, 11
    s_add_u32 m0, s74, 65536
    s_nop 0
    buffer_load_dwordx4 v2, s[8:11], s16 offen offset:0 lds
    buffer_load_dwordx4 v3, s[8:11], s16 offen offset:1024 lds
    buffer_load_dwordx4 v4, s[8:11], s16 offen offset:2048 lds
    buffer_load_dwordx4 v5, s[8:11], s16 offen offset:3072 lds
    buffer_load_dword v14, v12, s[56:59], s82 offen sc1
    s_waitcnt vmcnt(9)
    s_branch Lw_33
Lea_32:
    buffer_load_dword v14, v12, s[56:59], s82 offen sc1
    s_waitcnt vmcnt(13)
Lw_33:
    s_barrier
    s_waitcnt vmcnt(0)
    v_cmp_ne_u32 vcc, 1, v14
    s_cmp_gt_u32 s81, 0
    s_cselect_b32 s78, 0, 3
    s_lshl_b32 s17, s78, 17
    s_add_u32 m0, s75, 98304
    s_nop 0
    buffer_load_dwordx4 v6, s[12:15], s17 offen offset:0 lds
    buffer_load_dwordx4 v7, s[12:15], s17 offen offset:1024 lds
    buffer_load_dwordx4 v8, s[12:15], s17 offen offset:2048 lds
    buffer_load_dwordx4 v9, s[12:15], s17 offen offset:3072 lds
    s_cbranch_vccnz LslowH_35
    s_cmp_gt_u32 s81, 0
    s_cselect_b32 s78, 0, 3
    s_lshl_b32 s16, s78, 11
    s_add_u32 m0, s74, 98304
    s_nop 0
    buffer_load_dwordx4 v2, s[8:11], s16 offen offset:0 lds
    buffer_load_dwordx4 v3, s[8:11], s16 offen offset:1024 lds
    buffer_load_dwordx4 v4, s[8:11], s16 offen offset:2048 lds
    buffer_load_dwordx4 v5, s[8:11], s16 offen offset:3072 lds
    s_cmp_gt_u32 s81, 1
    s_cselect_b32 s78, 1, 4
    s_lshl_b32 s17, s78, 17
    s_add_u32 m0, s75, 131072
    s_nop 0
    buffer_load_dwordx4 v6, s[12:15], s17 offen offset:0 lds
    buffer_load_dwordx4 v7, s[12:15], s17 offen offset:1024 lds
    buffer_load_dwordx4 v8, s[12:15], s17 offen offset:2048 lds
    buffer_load_dwordx4 v9, s[12:15], s17 offen offset:3072 lds
    s_cmp_gt_u32 s81, 1
    s_cselect_b32 s78, 1, 4
    s_lshl_b32 s16, s78, 11
    s_add_u32 m0, s74, 131072
    s_nop 0
    buffer_load_dwordx4 v2, s[8:11], s16 offen offset:0 lds
    buffer_load_dwordx4 v3, s[8:11], s16 offen offset:1024 lds
    buffer_load_dwordx4 v4, s[8:11], s16 offen offset:2048 lds
    buffer_load_dwordx4 v5, s[8:11], s16 offen offset:3072 lds
    s_barrier
    s_cmp_gt_u32 s81, 2
    s_cselect_b32 s78, 2, 5
    s_lshl_b32 s17, s78, 17
    s_add_u32 m0, s75, 0
    s_nop 0
    buffer_load_dwordx4 v6, s[12:15], s17 offen offset:0 lds
    buffer_load_dwordx4 v7, s[12:15], s17 offen offset:1024 lds
    buffer_load_dwordx4 v8, s[12:15], s17 offen offset:2048 lds
    buffer_load_dwordx4 v9, s[12:15], s17 offen offset:3072 lds
    s_cmp_gt_u32 s81, 2
    s_cselect_b32 s78, 2, 5
    s_lshl_b32 s16, s78, 11
    s_add_u32 m0, s74, 0
    s_nop 0
    buffer_load_dwordx4 v2, s[8:11], s16 offen offset:0 lds
    buffer_load_dwordx4 v3, s[8:11], s16 offen offset:1024 lds
    buffer_load_dwordx4 v4, s[8:11], s16 offen offset:2048 lds
    buffer_load_dwordx4 v5, s[8:11], s16 offen offset:3072 lds
    s_barrier
    s_cmp_gt_u32 s81, 3
    s_cselect_b32 s78, 3, 6
    s_lshl_b32 s17, s78, 17
    s_add_u32 m0, s75, 32768
    s_nop 0
    buffer_load_dwordx4 v6, s[12:15], s17 offen offset:0 lds
    buffer_load_dwordx4 v7, s[12:15], s17 offen offset:1024 lds
    buffer_load_dwordx4 v8, s[12:15], s17 offen offset:2048 lds
    buffer_load_dwordx4 v9, s[12:15], s17 offen offset:3072 lds
    s_cmp_gt_u32 s81, 3
    s_cselect_b32 s78, 3, 6
    s_lshl_b32 s16, s78, 11
    s_add_u32 m0, s74, 32768
    s_nop 0
    buffer_load_dwordx4 v2, s[8:11], s16 offen offset:0 lds
    buffer_load_dwordx4 v3, s[8:11], s16 offen offset:1024 lds
    buffer_load_dwordx4 v4, s[8:11], s16 offen offset:2048 lds
    buffer_load_dwordx4 v5, s[8:11], s16 offen offset:3072 lds
    s_branch LjoinH_36
LslowH_35:
    s_cmp_gt_u32 s81, 1
    s_cselect_b32 s78, 1, 4
    s_lshl_b32 s17, s78, 17
    s_add_u32 m0, s75, 131072
    s_nop 0
    buffer_load_dwordx4 v6, s[12:15], s17 offen offset:0 lds
    buffer_load_dwordx4 v7, s[12:15], s17 offen offset:1024 lds
    buffer_load_dwordx4 v8, s[12:15], s17 offen offset:2048 lds
    buffer_load_dwordx4 v9, s[12:15], s17 offen offset:3072 lds
    s_barrier
    s_cmp_gt_u32 s81, 2
    s_cselect_b32 s78, 2, 5
    s_lshl_b32 s17, s78, 17
    s_add_u32 m0, s75, 0
    s_nop 0
    buffer_load_dwordx4 v6, s[12:15], s17 offen offset:0 lds
    buffer_load_dwordx4 v7, s[12:15], s17 offen offset:1024 lds
    buffer_load_dwordx4 v8, s[12:15], s17 offen offset:2048 lds
    buffer_load_dwordx4 v9, s[12:15], s17 offen offset:3072 lds
    s_barrier
    s_cmp_gt_u32 s81, 3
    s_cselect_b32 s78, 3, 6
    s_lshl_b32 s17, s78, 17
    s_add_u32 m0, s75, 32768
    s_nop 0
    buffer_load_dwordx4 v6, s[12:15], s17 offen offset:0 lds
    buffer_load_dwordx4 v7, s[12:15], s17 offen offset:1024 lds
    buffer_load_dwordx4 v8, s[12:15], s17 offen offset:2048 lds
    buffer_load_dwordx4 v9, s[12:15], s17 offen offset:3072 lds
    v_and_b32 v13, 7, v1
    v_lshlrev_b32 v13, 2, v13
    s_mov_b32 s78, 0
Lpf_37:
    buffer_load_dword v14, v13, s[56:59], s82 offen sc1
    s_waitcnt vmcnt(0)
    v_cmp_ne_u32 vcc, 1, v14
    s_cbranch_vccz Lpo_38
    s_sleep 1
    s_add_u32 s78, s78, 1
    s_cmp_lt_u32 s78, 262144
    s_cbranch_scc1 Lpf_37
Lpo_38:
    s_cmp_gt_u32 s81, 0
    s_cselect_b32 s78, 0, 3
    s_lshl_b32 s16, s78, 11
    s_add_u32 m0, s74, 98304
    s_nop 0
    buffer_load_dwordx4 v2, s[8:11], s16 offen offset:0 lds
    buffer_load_dwordx4 v3, s[8:11], s16 offen offset:1024 lds
    buffer_load_dwordx4 v4, s[8:11], s16 offen offset:2048 lds
    buffer_load_dwordx4 v5, s[8:11], s16 offen offset:3072 lds
    s_cmp_gt_u32 s81, 1
    s_cselect_b32 s78, 1, 4
    s_lshl_b32 s16, s78, 11
    s_add_u32 m0, s74, 131072
    s_nop 0
    buffer_load_dwordx4 v2, s[8:11], s16 offen offset:0 lds
    buffer_load_dwordx4 v3, s[8:11], s16 offen offset:1024 lds
    buffer_load_dwordx4 v4, s[8:11], s16 offen offset:2048 lds
    buffer_load_dwordx4 v5, s[8:11], s16 offen offset:3072 lds
    s_cmp_gt_u32 s81, 2
    s_cselect_b32 s78, 2, 5
    s_lshl_b32 s16, s78, 11
    s_add_u32 m0, s74, 0
    s_nop 0
    buffer_load_dwordx4 v2, s[8:11], s16 offen offset:0 lds
    buffer_load_dwordx4 v3, s[8:11], s16 offen offset:1024 lds
    buffer_load_dwordx4 v4, s[8:11], s16 offen offset:2048 lds
    buffer_load_dwordx4 v5, s[8:11], s16 offen offset:3072 lds
    s_cmp_gt_u32 s81, 3
    s_cselect_b32 s78, 3, 6
    s_lshl_b32 s16, s78, 11
    s_add_u32 m0, s74, 32768
    s_nop 0
    buffer_load_dwordx4 v2, s[8:11], s16 offen offset:0 lds
    buffer_load_dwordx4 v3, s[8:11], s16 offen offset:1024 lds
    buffer_load_dwordx4 v4, s[8:11], s16 offen offset:2048 lds
    buffer_load_dwordx4 v5, s[8:11], s16 offen offset:3072 lds
    s_waitcnt vmcnt(0)
LjoinH_36:
    s_cmp_lg_u32 s28, 0
    s_cbranch_scc1 Lw0_40
    s_mov_b64 exec, 1
    v_mov_b32 v13, 128
    v_mov_b32 v14, 1
    global_atomic_add v13, v14, s[52:53] sc1
    s_mov_b64 exec, -1
Lw0_40:
Lna_39:
    s_and_b32 s24, s2, 0xfe
    s_add_u32 s25, s24, 1
    s_waitcnt vmcnt(24)
    s_barrier
    s_cmp_gt_u32 s81, 4
    s_cselect_b32 s78, 4, 7
    s_lshl_b32 s17, s78, 17
    s_add_u32 m0, s75, 65536
    s_nop 0
    buffer_load_dwordx4 v6, s[12:15], s17 offen offset:0 lds
    buffer_load_dwordx4 v7, s[12:15], s17 offen offset:1024 lds
    buffer_load_dwordx4 v8, s[12:15], s17 offen offset:2048 lds
    buffer_load_dwordx4 v9, s[12:15], s17 offen offset:3072 lds
    s_cmp_gt_u32 s81, 4
    s_cselect_b32 s78, 4, 7
    s_lshl_b32 s16, s78, 11
    s_add_u32 m0, s74, 65536
    s_nop 0
    buffer_load_dwordx4 v2, s[8:11], s16 offen offset:0 lds
    buffer_load_dwordx4 v3, s[8:11], s16 offen offset:1024 lds
    buffer_load_dwordx4 v4, s[8:11], s16 offen offset:2048 lds
    buffer_load_dwordx4 v5, s[8:11], s16 offen offset:3072 lds
    s_waitcnt vmcnt(24)
    s_barrier
    s_cmp_gt_u32 s81, 5
    s_cselect_b32 s78, 5, 8
    s_lshl_b32 s17, s78, 17
    s_add_u32 m0, s75, 98304
    s_nop 0
    buffer_load_dwordx4 v6, s[12:15], s17 offen offset:0 lds
    buffer_load_dwordx4 v7, s[12:15], s17 offen offset:1024 lds
    buffer_load_dwordx4 v8, s[12:15], s17 offen offset:2048 lds
    buffer_load_dwordx4 v9, s[12:15], s17 offen offset:3072 lds
    s_cmp_gt_u32 s81, 5
    s_cselect_b32 s78, 5, 8
    s_lshl_b32 s16, s78, 11
    s_add_u32 m0, s74, 98304
    s_nop 0
    buffer_load_dwordx4 v2, s[8:11], s16 offen offset:0 lds
    buffer_load_dwordx4 v3, s[8:11], s16 offen offset:1024 lds
    buffer_load_dwordx4 v4, s[8:11], s16 offen offset:2048 lds
    buffer_load_dwordx4 v5, s[8:11], s16 offen offset:3072 lds
    s_waitcnt vmcnt(24)
    s_barrier
    s_cmp_gt_u32 s81, 6
    s_cselect_b32 s78, 6, 9
    s_lshl_b32 s17, s78, 17
    s_add_u32 m0, s75, 131072
    s_nop 0
    buffer_load_dwordx4 v6, s[12:15], s17 offen offset:0 lds
    buffer_load_dwordx4 v7, s[12:15], s17 offen offset:1024 lds
    buffer_load_dwordx4 v8, s[12:15], s17 offen offset:2048 lds
    buffer_load_dwordx4 v9, s[12:15], s17 offen offset:3072 lds
    s_cmp_gt_u32 s81, 6
    s_cselect_b32 s78, 6, 9
    s_lshl_b32 s16, s78, 11
    s_add_u32 m0, s74, 131072
    s_nop 0
    buffer_load_dwordx4 v2, s[8:11], s16 offen offset:0 lds
    buffer_load_dwordx4 v3, s[8:11], s16 offen offset:1024 lds
    buffer_load_dwordx4 v4, s[8:11], s16 offen offset:2048 lds
    buffer_load_dwordx4 v5, s[8:11], s16 offen offset:3072 lds
    v_and_b32 v16, 15, v1
    v_lshrrev_b32 v17, 4, v1
    v_cvt_f32_u32 v18, v16
    v_lshlrev_b32 v19, 2, v17
    v_cvt_f32_u32 v19, v19
    v_mul_f32 v76, 0x3d800000, v18
    v_mul_f32 v77, v19, v76
    v_mov_b32 v79, v77
    v_fmamk_f32 v81, v76, 0x3f800000, v77
    v_fmamk_f32 v83, v76, 0x40000000, v77
    v_fmamk_f32 v85, v76, 0x40400000, v77
    v_cos_f32 v78, v79
    v_sin_f32 v79, v79
    v_cos_f32 v80, v81
    v_sin_f32 v81, v81
    v_cos_f32 v82, v83
    v_sin_f32 v83, v83
    v_cos_f32 v84, v85
    v_sin_f32 v85, v85
    s_waitcnt vmcnt(24)
    s_barrier
    s_cmp_gt_u32 s81, 7
    s_cselect_b32 s78, 7, 10
    s_lshl_b32 s17, s78, 17
    s_add_u32 m0, s75, 0
    s_nop 0
    buffer_load_dwordx4 v6, s[12:15], s17 offen offset:0 lds
    buffer_load_dwordx4 v7, s[12:15], s17 offen offset:1024 lds
    buffer_load_dwordx4 v8, s[12:15], s17 offen offset:2048 lds
    buffer_load_dwordx4 v9, s[12:15], s17 offen offset:3072 lds
    s_cmp_gt_u32 s81, 7
    s_cselect_b32 s78, 7, 10
    s_lshl_b32 s16, s78, 11
    s_add_u32 m0, s74, 0
    s_nop 0
    buffer_load_dwordx4 v2, s[8:11], s16 offen offset:0 lds
    buffer_load_dwordx4 v3, s[8:11], s16 offen offset:1024 lds
    buffer_load_dwordx4 v4, s[8:11], s16 offen offset:2048 lds
    buffer_load_dwordx4 v5, s[8:11], s16 offen offset:3072 lds
    v_cvt_pk_bf16_f32 v20, v78, v79
    v_cvt_pk_bf16_f32 v24, -v79, v78
    v_cvt_pk_bf16_f32 v21, v80, v81
    v_cvt_pk_bf16_f32 v25, -v81, v80
    v_cvt_pk_bf16_f32 v22, v82, v83
    v_cvt_pk_bf16_f32 v26, -v83, v82
    v_cvt_pk_bf16_f32 v23, v84, v85
    v_cvt_pk_bf16_f32 v27, -v85, v84
    v_lshlrev_b32 v86, 26, v1
    v_and_b32 v86, 0x80000000, v86
    v_xor_b32 v20, v86, v20
    v_xor_b32 v24, v86, v24
    v_xor_b32 v21, v86, v21
    v_xor_b32 v25, v86, v25
    v_xor_b32 v22, v86, v22
    v_xor_b32 v26, v86, v26
    v_xor_b32 v23, v86, v23
    v_xor_b32 v27, v86, v27
    v_mul_f32 v76, 0x3b000000, v18
    s_waitcnt vmcnt(24)
    s_barrier
    s_cmp_gt_u32 s81, 8
    s_cselect_b32 s78, 8, 11
    s_lshl_b32 s17, s78, 17
    s_add_u32 m0, s75, 32768
    s_nop 0
    buffer_load_dwordx4 v6, s[12:15], s17 offen offset:0 lds
    buffer_load_dwordx4 v7, s[12:15], s17 offen offset:1024 lds
    buffer_load_dwordx4 v8, s[12:15], s17 offen offset:2048 lds
    buffer_load_dwordx4 v9, s[12:15], s17 offen offset:3072 lds
    s_cmp_gt_u32 s81, 8
    s_cselect_b32 s78, 8, 11
    s_lshl_b32 s16, s78, 11
    s_add_u32 m0, s74, 32768
    s_nop 0
    buffer_load_dwordx4 v2, s[8:11], s16 offen offset:0 lds
    buffer_load_dwordx4 v3, s[8:11], s16 offen offset:1024 lds
    buffer_load_dwordx4 v4, s[8:11], s16 offen offset:2048 lds
    buffer_load_dwordx4 v5, s[8:11], s16 offen offset:3072 lds
    v_mul_f32 v77, v19, v76
    v_mov_b32 v29, v77
    v_fmamk_f32 v31, v76, 0x3f800000, v77
    v_fmamk_f32 v33, v76, 0x40000000, v77
    v_fmamk_f32 v35, v76, 0x40400000, v77
    v_fmamk_f32 v37, v76, 0x41800000, v77
    v_fmamk_f32 v39, v76, 0x41880000, v77
    v_fmamk_f32 v41, v76, 0x41900000, v77
    v_fmamk_f32 v43, v76, 0x41980000, v77
    v_cos_f32 v28, v29
    v_sin_f32 v29, v29
    v_cos_f32 v30, v31
    v_sin_f32 v31, v31
    v_cos_f32 v32, v33
    v_sin_f32 v33, v33
    v_cos_f32 v34, v35
    v_sin_f32 v35, v35
    v_cos_f32 v36, v37
    v_sin_f32 v37, v37
    s_waitcnt vmcnt(24)
    s_barrier
    s_cmp_gt_u32 s81, 9
    s_cselect_b32 s78, 9, 12
    s_lshl_b32 s17, s78, 17
    s_add_u32 m0, s75, 65536
    s_nop 0
    buffer_load_dwordx4 v6, s[12:15], s17 offen offset:0 lds
    buffer_load_dwordx4 v7, s[12:15], s17 offen offset:1024 lds
    buffer_load_dwordx4 v8, s[12:15], s17 offen offset:2048 lds
    buffer_load_dwordx4 v9, s[12:15], s17 offen offset:3072 lds
    s_cmp_gt_u32 s81, 9
    s_cselect_b32 s78, 9, 12
    s_lshl_b32 s16, s78, 11
    s_add_u32 m0, s74, 65536
    s_nop 0
    buffer_load_dwordx4 v2, s[8:11], s16 offen offset:0 lds
    buffer_load_dwordx4 v3, s[8:11], s16 offen offset:1024 lds
    buffer_load_dwordx4 v4, s[8:11], s16 offen offset:2048 lds
    buffer_load_dwordx4 v5, s[8:11], s16 offen offset:3072 lds
    v_cos_f32 v38, v39
    v_sin_f32 v39, v39
    v_cos_f32 v40, v41
    v_sin_f32 v41, v41
    v_cos_f32 v42, v43
    v_sin_f32 v43, v43
    v_mul_f32 v76, 0x3d000000, v18
    v_mul_f32 v77, v19, v76
    v_mov_b32 v79, v77
    v_fmamk_f32 v81, v76, 0x3f800000, v77
    v_fmamk_f32 v83, v76, 0x40000000, v77
    v_fmamk_f32 v85, v76, 0x40400000, v77
    v_cos_f32 v78, v79
    v_sin_f32 v79, v79
    v_cos_f32 v80, v81
    v_sin_f32 v81, v81
    v_cos_f32 v82, v83
    v_sin_f32 v83, v83
    v_cos_f32 v84, v85
    s_waitcnt vmcnt(24)
    s_barrier
    s_cmp_gt_u32 s81, 10
    s_cselect_b32 s78, 10, 13
    s_lshl_b32 s17, s78, 17
    s_add_u32 m0, s75, 98304
    s_nop 0
    buffer_load_dwordx4 v6, s[12:15], s17 offen offset:0 lds
    buffer_load_dwordx4 v7, s[12:15], s17 offen offset:1024 lds
    buffer_load_dwordx4 v8, s[12:15], s17 offen offset:2048 lds
    buffer_load_dwordx4 v9, s[12:15], s17 offen offset:3072 lds
    s_cmp_gt_u32 s81, 10
    s_cselect_b32 s78, 10, 13
    s_lshl_b32 s16, s78, 11
    s_add_u32 m0, s74, 98304
    s_nop 0
    buffer_load_dwordx4 v2, s[8:11], s16 offen offset:0 lds
    buffer_load_dwordx4 v3, s[8:11], s16 offen offset:1024 lds
    buffer_load_dwordx4 v4, s[8:11], s16 offen offset:2048 lds
    buffer_load_dwordx4 v5, s[8:11], s16 offen offset:3072 lds
    v_sin_f32 v85, v85
    v_and_b32 v86, 1, v1
    v_mul_u32_u24 v86, 0x8000, v86
    v_lshl_or_b32 v86, v86, 16, v86
    v_cvt_pk_bf16_f32 v44, v78, v79
    v_cvt_pk_bf16_f32 v48, v79, -v78
    v_cvt_pk_bf16_f32 v45, v80, v81
    v_cvt_pk_bf16_f32 v49, v81, -v80
    v_cvt_pk_bf16_f32 v46, v82, v83
    v_cvt_pk_bf16_f32 v50, v83, -v82
    v_cvt_pk_bf16_f32 v47, v84, v85
    v_cvt_pk_bf16_f32 v51, v85, -v84
    v_xor_b32 v52, v86, v44
    v_xor_b32 v53, v86, v45
    v_xor_b32 v54, v86, v46
    v_xor_b32 v55, v86, v47
    v_xor_b32 v56, v86, v48
    v_xor_b32 v57, v86, v49
    v_xor_b32 v58, v86, v50
    s_waitcnt vmcnt(24)
    s_barrier
    s_cmp_gt_u32 s81, 11
    s_cselect_b32 s78, 11, 14
    s_lshl_b32 s17, s78, 17
    s_add_u32 m0, s75, 131072
    s_nop 0
    buffer_load_dwordx4 v6, s[12:15], s17 offen offset:0 lds
    buffer_load_dwordx4 v7, s[12:15], s17 offen offset:1024 lds
    buffer_load_dwordx4 v8, s[12:15], s17 offen offset:2048 lds
    buffer_load_dwordx4 v9, s[12:15], s17 offen offset:3072 lds
    s_cmp_gt_u32 s81, 11
    s_cselect_b32 s78, 11, 14
    s_lshl_b32 s16, s78, 11
    s_add_u32 m0, s74, 131072
    s_nop 0
    buffer_load_dwordx4 v2, s[8:11], s16 offen offset:0 lds
    buffer_load_dwordx4 v3, s[8:11], s16 offen offset:1024 lds
    buffer_load_dwordx4 v4, s[8:11], s16 offen offset:2048 lds
    buffer_load_dwordx4 v5, s[8:11], s16 offen offset:3072 lds
    v_xor_b32 v59, v86, v51
    v_cvt_pk_bf16_f32 v60, v78, v79
    v_cvt_pk_bf16_f32 v64, v79, -v78
    v_cvt_pk_bf16_f32 v61, -v80, -v81
    v_cvt_pk_bf16_f32 v65, -v81, v80
    v_cvt_pk_bf16_f32 v62, v82, v83
    v_cvt_pk_bf16_f32 v66, v83, -v82
    v_cvt_pk_bf16_f32 v63, -v84, -v85
    v_cvt_pk_bf16_f32 v67, -v85, v84
    v_xor_b32 v68, v86, v60
    v_xor_b32 v69, v86, v61
    v_xor_b32 v70, v86, v62
    v_xor_b32 v71, v86, v63
    v_xor_b32 v72, v86, v64
    v_xor_b32 v73, v86, v65
    v_xor_b32 v74, v86, v66
    v_xor_b32 v75, v86, v67
    s_waitcnt vmcnt(24)
    s_barrier
    s_cmp_gt_u32 s81, 12
    s_cselect_b32 s78, 12, 15
    s_lshl_b32 s17, s78, 17
    s_add_u32 m0, s75, 0
    s_nop 0
    buffer_load_dwordx4 v6, s[12:15], s17 offen offset:0 lds
    buffer_load_dwordx4 v7, s[12:15], s17 offen offset:1024 lds
    buffer_load_dwordx4 v8, s[12:15], s17 offen offset:2048 lds
    buffer_load_dwordx4 v9, s[12:15], s17 offen offset:3072 lds
    s_cmp_gt_u32 s81, 12
    s_cselect_b32 s78, 12, 15
    s_lshl_b32 s16, s78, 11
    s_add_u32 m0, s74, 0
    s_nop 0
    buffer_load_dwordx4 v2, s[8:11], s16 offen offset:0 lds
    buffer_load_dwordx4 v3, s[8:11], s16 offen offset:1024 lds
    buffer_load_dwordx4 v4, s[8:11], s16 offen offset:2048 lds
    buffer_load_dwordx4 v5, s[8:11], s16 offen offset:3072 lds
    s_waitcnt vmcnt(24)
    s_barrier
    s_cmp_gt_u32 s81, 13
    s_cselect_b32 s78, 13, 16
    s_lshl_b32 s17, s78, 17
    s_add_u32 m0, s75, 32768
    s_nop 0
    buffer_load_dwordx4 v6, s[12:15], s17 offen offset:0 lds
    buffer_load_dwordx4 v7, s[12:15], s17 offen offset:1024 lds
    buffer_load_dwordx4 v8, s[12:15], s17 offen offset:2048 lds
    buffer_load_dwordx4 v9, s[12:15], s17 offen offset:3072 lds
    s_cmp_gt_u32 s81, 13
    s_cselect_b32 s78, 13, 16
    s_lshl_b32 s16, s78, 11
    s_add_u32 m0, s74, 32768
    s_nop 0
    buffer_load_dwordx4 v2, s[8:11], s16 offen offset:0 lds
    buffer_load_dwordx4 v3, s[8:11], s16 offen offset:1024 lds
    buffer_load_dwordx4 v4, s[8:11], s16 offen offset:2048 lds
    buffer_load_dwordx4 v5, s[8:11], s16 offen offset:3072 lds
    s_waitcnt vmcnt(24)
    s_barrier
    s_cmp_gt_u32 s81, 14
    s_cselect_b32 s78, 14, 17
    s_lshl_b32 s17, s78, 17
    s_add_u32 m0, s75, 65536
    s_nop 0
    buffer_load_dwordx4 v6, s[12:15], s17 offen offset:0 lds
    buffer_load_dwordx4 v7, s[12:15], s17 offen offset:1024 lds
    buffer_load_dwordx4 v8, s[12:15], s17 offen offset:2048 lds
    buffer_load_dwordx4 v9, s[12:15], s17 offen offset:3072 lds
    s_cmp_gt_u32 s81, 14
    s_cselect_b32 s78, 14, 17
    s_lshl_b32 s16, s78, 11
    s_add_u32 m0, s74, 65536
    s_nop 0
    buffer_load_dwordx4 v2, s[8:11], s16 offen offset:0 lds
    buffer_load_dwordx4 v3, s[8:11], s16 offen offset:1024 lds
    buffer_load_dwordx4 v4, s[8:11], s16 offen offset:2048 lds
    buffer_load_dwordx4 v5, s[8:11], s16 offen offset:3072 lds
    s_waitcnt vmcnt(24)
    s_barrier
    s_cmp_gt_u32 s81, 15
    s_cselect_b32 s78, 15, 18
    s_lshl_b32 s17, s78, 17
    s_add_u32 m0, s75, 98304
    s_nop 0
    buffer_load_dwordx4 v6, s[12:15], s17 offen offset:0 lds
    buffer_load_dwordx4 v7, s[12:15], s17 offen offset:1024 lds
    buffer_load_dwordx4 v8, s[12:15], s17 offen offset:2048 lds
    buffer_load_dwordx4 v9, s[12:15], s17 offen offset:3072 lds
    s_cmp_gt_u32 s81, 15
    s_cselect_b32 s78, 15, 18
    s_lshl_b32 s16, s78, 11
    s_add_u32 m0, s74, 98304
    s_nop 0
    buffer_load_dwordx4 v2, s[8:11], s16 offen offset:0 lds
    buffer_load_dwordx4 v3, s[8:11], s16 offen offset:1024 lds
    buffer_load_dwordx4 v4, s[8:11], s16 offen offset:2048 lds
    buffer_load_dwordx4 v5, s[8:11], s16 offen offset:3072 lds
    s_waitcnt vmcnt(24)
    s_barrier
    s_cmp_gt_u32 s81, 16
    s_cselect_b32 s78, 16, 19
    s_lshl_b32 s17, s78, 17
    s_add_u32 m0, s75, 131072
    s_nop 0
    buffer_load_dwordx4 v6, s[12:15], s17 offen offset:0 lds
    buffer_load_dwordx4 v7, s[12:15], s17 offen offset:1024 lds
    buffer_load_dwordx4 v8, s[12:15], s17 offen offset:2048 lds
    buffer_load_dwordx4 v9, s[12:15], s17 offen offset:3072 lds
    s_cmp_gt_u32 s81, 16
    s_cselect_b32 s78, 16, 19
    s_lshl_b32 s16, s78, 11
    s_add_u32 m0, s74, 131072
    s_nop 0
    buffer_load_dwordx4 v2, s[8:11], s16 offen offset:0 lds
    buffer_load_dwordx4 v3, s[8:11], s16 offen offset:1024 lds
    buffer_load_dwordx4 v4, s[8:11], s16 offen offset:2048 lds
    buffer_load_dwordx4 v5, s[8:11], s16 offen offset:3072 lds
    s_waitcnt vmcnt(24)
    s_barrier
    s_cmp_gt_u32 s81, 17
    s_cselect_b32 s78, 17, 20
    s_lshl_b32 s17, s78, 17
    s_add_u32 m0, s75, 0
    s_nop 0
    buffer_load_dwordx4 v6, s[12:15], s17 offen offset:0 lds
    buffer_load_dwordx4 v7, s[12:15], s17 offen offset:1024 lds
    buffer_load_dwordx4 v8, s[12:15], s17 offen offset:2048 lds
    buffer_load_dwordx4 v9, s[12:15], s17 offen offset:3072 lds
    s_cmp_gt_u32 s81, 17
    s_cselect_b32 s78, 17, 20
    s_lshl_b32 s16, s78, 11
    s_add_u32 m0, s74, 0
    s_nop 0
    buffer_load_dwordx4 v2, s[8:11], s16 offen offset:0 lds
    buffer_load_dwordx4 v3, s[8:11], s16 offen offset:1024 lds
    buffer_load_dwordx4 v4, s[8:11], s16 offen offset:2048 lds
    buffer_load_dwordx4 v5, s[8:11], s16 offen offset:3072 lds
    s_waitcnt vmcnt(24)
    s_barrier
    s_cmp_gt_u32 s81, 18
    s_cselect_b32 s78, 18, 21
    s_lshl_b32 s17, s78, 17
    s_add_u32 m0, s75, 32768
    s_nop 0
    buffer_load_dwordx4 v6, s[12:15], s17 offen offset:0 lds
    buffer_load_dwordx4 v7, s[12:15], s17 offen offset:1024 lds
    buffer_load_dwordx4 v8, s[12:15], s17 offen offset:2048 lds
    buffer_load_dwordx4 v9, s[12:15], s17 offen offset:3072 lds
    s_cmp_gt_u32 s81, 18
    s_cselect_b32 s78, 18, 21
    s_lshl_b32 s16, s78, 11
    s_add_u32 m0, s74, 32768
    s_nop 0
    buffer_load_dwordx4 v2, s[8:11], s16 offen offset:0 lds
    buffer_load_dwordx4 v3, s[8:11], s16 offen offset:1024 lds
    buffer_load_dwordx4 v4, s[8:11], s16 offen offset:2048 lds
    buffer_load_dwordx4 v5, s[8:11], s16 offen offset:3072 lds
    s_waitcnt vmcnt(24)
    s_barrier
    s_cmp_gt_u32 s81, 19
    s_cselect_b32 s78, 19, 22
    s_lshl_b32 s17, s78, 17
    s_add_u32 m0, s75, 65536
    s_nop 0
    buffer_load_dwordx4 v6, s[12:15], s17 offen offset:0 lds
    buffer_load_dwordx4 v7, s[12:15], s17 offen offset:1024 lds
    buffer_load_dwordx4 v8, s[12:15], s17 offen offset:2048 lds
    buffer_load_dwordx4 v9, s[12:15], s17 offen offset:3072 lds
    s_cmp_gt_u32 s81, 19
    s_cselect_b32 s78, 19, 22
    s_lshl_b32 s16, s78, 11
    s_add_u32 m0, s74, 65536
    s_nop 0
    buffer_load_dwordx4 v2, s[8:11], s16 offen offset:0 lds
    buffer_load_dwordx4 v3, s[8:11], s16 offen offset:1024 lds
    buffer_load_dwordx4 v4, s[8:11], s16 offen offset:2048 lds
    buffer_load_dwordx4 v5, s[8:11], s16 offen offset:3072 lds
    s_waitcnt vmcnt(24)
    s_barrier
    s_cmp_gt_u32 s81, 20
    s_cselect_b32 s78, 20, 23
    s_lshl_b32 s17, s78, 17
    s_add_u32 m0, s75, 98304
    s_nop 0
    buffer_load_dwordx4 v6, s[12:15], s17 offen offset:0 lds
    buffer_load_dwordx4 v7, s[12:15], s17 offen offset:1024 lds
    buffer_load_dwordx4 v8, s[12:15], s17 offen offset:2048 lds
    buffer_load_dwordx4 v9, s[12:15], s17 offen offset:3072 lds
    s_cmp_gt_u32 s81, 20
    s_cselect_b32 s78, 20, 23
    s_lshl_b32 s16, s78, 11
    s_add_u32 m0, s74, 98304
    s_nop 0
    buffer_load_dwordx4 v2, s[8:11], s16 offen offset:0 lds
    buffer_load_dwordx4 v3, s[8:11], s16 offen offset:1024 lds
    buffer_load_dwordx4 v4, s[8:11], s16 offen offset:2048 lds
    buffer_load_dwordx4 v5, s[8:11], s16 offen offset:3072 lds
    s_waitcnt vmcnt(24)
    s_barrier
    s_cmp_gt_u32 s81, 21
    s_cselect_b32 s78, 21, 24
    s_lshl_b32 s17, s78, 17
    s_add_u32 m0, s75, 131072
    s_nop 0
    buffer_load_dwordx4 v6, s[12:15], s17 offen offset:0 lds
    buffer_load_dwordx4 v7, s[12:15], s17 offen offset:1024 lds
    buffer_load_dwordx4 v8, s[12:15], s17 offen offset:2048 lds
    buffer_load_dwordx4 v9, s[12:15], s17 offen offset:3072 lds
    s_cmp_gt_u32 s81, 21
    s_cselect_b32 s78, 21, 24
    s_lshl_b32 s16, s78, 11
    s_add_u32 m0, s74, 131072
    s_nop 0
    buffer_load_dwordx4 v2, s[8:11], s16 offen offset:0 lds
    buffer_load_dwordx4 v3, s[8:11], s16 offen offset:1024 lds
    buffer_load_dwordx4 v4, s[8:11], s16 offen offset:2048 lds
    buffer_load_dwordx4 v5, s[8:11], s16 offen offset:3072 lds
    s_waitcnt vmcnt(24)
    s_barrier
    s_cmp_gt_u32 s81, 22
    s_cselect_b32 s78, 22, 25
    s_lshl_b32 s17, s78, 17
    s_add_u32 m0, s75, 0
    s_nop 0
    buffer_load_dwordx4 v6, s[12:15], s17 offen offset:0 lds
    buffer_load_dwordx4 v7, s[12:15], s17 offen offset:1024 lds
    buffer_load_dwordx4 v8, s[12:15], s17 offen offset:2048 lds
    buffer_load_dwordx4 v9, s[12:15], s17 offen offset:3072 lds
    s_cmp_gt_u32 s81, 22
    s_cselect_b32 s78, 22, 25
    s_lshl_b32 s16, s78, 11
    s_add_u32 m0, s74, 0
    s_nop 0
    buffer_load_dwordx4 v2, s[8:11], s16 offen offset:0 lds
    buffer_load_dwordx4 v3, s[8:11], s16 offen offset:1024 lds
    buffer_load_dwordx4 v4, s[8:11], s16 offen offset:2048 lds
    buffer_load_dwordx4 v5, s[8:11], s16 offen offset:3072 lds
    s_waitcnt vmcnt(24)
    s_barrier
    s_cmp_gt_u32 s81, 23
    s_cselect_b32 s78, 23, 26
    s_lshl_b32 s17, s78, 17
    s_add_u32 m0, s75, 32768
    s_nop 0
    buffer_load_dwordx4 v6, s[12:15], s17 offen offset:0 lds
    buffer_load_dwordx4 v7, s[12:15], s17 offen offset:1024 lds
    buffer_load_dwordx4 v8, s[12:15], s17 offen offset:2048 lds
    buffer_load_dwordx4 v9, s[12:15], s17 offen offset:3072 lds
    s_cmp_gt_u32 s81, 23
    s_cselect_b32 s78, 23, 26
    s_lshl_b32 s16, s78, 11
    s_add_u32 m0, s74, 32768
    s_nop 0
    buffer_load_dwordx4 v2, s[8:11], s16 offen offset:0 lds
    buffer_load_dwordx4 v3, s[8:11], s16 offen offset:1024 lds
    buffer_load_dwordx4 v4, s[8:11], s16 offen offset:2048 lds
    buffer_load_dwordx4 v5, s[8:11], s16 offen offset:3072 lds
    s_waitcnt vmcnt(24)
    s_barrier
    s_cmp_gt_u32 s81, 24
    s_cselect_b32 s78, 24, 27
    s_lshl_b32 s17, s78, 17
    s_add_u32 m0, s75, 65536
    s_nop 0
    buffer_load_dwordx4 v6, s[12:15], s17 offen offset:0 lds
    buffer_load_dwordx4 v7, s[12:15], s17 offen offset:1024 lds
    buffer_load_dwordx4 v8, s[12:15], s17 offen offset:2048 lds
    buffer_load_dwordx4 v9, s[12:15], s17 offen offset:3072 lds
    s_cmp_gt_u32 s81, 24
    s_cselect_b32 s78, 24, 27
    s_lshl_b32 s16, s78, 11
    s_add_u32 m0, s74, 65536
    s_nop 0
    buffer_load_dwordx4 v2, s[8:11], s16 offen offset:0 lds
    buffer_load_dwordx4 v3, s[8:11], s16 offen offset:1024 lds
    buffer_load_dwordx4 v4, s[8:11], s16 offen offset:2048 lds
    buffer_load_dwordx4 v5, s[8:11], s16 offen offset:3072 lds
    s_waitcnt vmcnt(24)
    s_barrier
    v_and_b32 v13, 15, v1
    v_lshlrev_b32 v13, 2, v13
    v_add_u32 v13, 98304, v13
    v_mov_b32 v14, 0
    ds_write_b32 v13, v14
    s_waitcnt lgkmcnt(0)
    s_waitcnt vmcnt(16)
    s_barrier
    s_waitcnt vmcnt(8)
    s_bitcmp1_b32 s2, 0
    s_cbranch_scc1 Lnp_41
    s_cmp_lg_u32 s28, 0
    s_cbranch_scc1 Lnp_41
    v_mov_b32 v13, 128
    s_mov_b32 s6, 0
Lpd_42:
    global_load_dword v14, v13, s[52:53] sc1
    s_waitcnt vmcnt(0)
    v_readfirstlane_b32 s7, v14
    s_nop 0
    s_cmp_ge_u32 s7, 256
    s_cbranch_scc1 Lpo_43
    s_sleep 2
    s_add_u32 s6, s6, 1
    s_cmp_lt_u32 s6, 262144
    s_cbranch_scc1 Lpd_42
Lpo_43:
Lnp_41:
    s_barrier
    v_lshrrev_b32 v76, 2, v1
    v_lshlrev_b32 v76, 14, v76
    v_and_b32 v77, 2, v1
    v_lshl_add_u32 v76, v77, 9, v76
    v_and_b32 v77, 1, v1
    v_lshl_add_u32 v76, v77, 4, v76
    v_mov_b32 v79, 0
    s_lshr_b32 s3, s24, 6
    s_lshl_b32 s3, s3, 12
    s_bfe_u32 s4, s24, 0x10002
    s_lshl_b32 s4, s4, 11
    s_add_u32 s3, s3, s4
    s_and_b32 s4, s24, 3
    s_lshl_b32 s4, s4, 8
    s_add_u32 s3, s3, s4
    s_bfe_u32 s4, s24, 0x30003
    s_lshl_b32 s4, s4, 5
    s_add_u32 s3, s3, s4
    s_add_u32 s3, s3, 27262976
    s_lshl_b32 s4, s28, 20
    s_add_u32 s3, s3, s4

    s_bitcmp1_b32 s2, 0
    s_cbranch_scc1 Lz_45
    buffer_load_dwordx4 v[88:91], v76, s[56:59], s3 offen sc1
Lz_45:
    s_add_u32 s3, s3, 262144
    s_bitcmp1_b32 s2, 0
    s_cbranch_scc1 Lz_46
    buffer_load_dwordx4 v[92:95], v76, s[56:59], s3 offen sc1
Lz_46:
    s_add_u32 s3, s3, 262144
    s_bitcmp1_b32 s2, 0
    s_cbranch_scc1 Lz_47
    buffer_load_dwordx4 v[96:99], v76, s[56:59], s3 offen sc1
Lz_47:
    s_add_u32 s3, s3, 262144
    s_bitcmp1_b32 s2, 0
    s_cbranch_scc1 Lz_48
    buffer_load_dwordx4 v[100:103], v76, s[56:59], s3 offen sc1
Lz_48:
    s_add_u32 s3, s3, 262144
    s_lshr_b32 s20, s24, 3
    s_lshl_b32 s20, s20, 6
    s_and_b32 s4, s24, 7
    s_lshl_b32 s4, s4, 2
    s_add_u32 s20, s20, s4
    s_lshr_b32 s4, s28, 1
    s_lshl_b32 s4, s4, 5
    s_add_u32 s20, s20, s4
    s_and_b32 s4, s28, 1
    s_lshl_b32 s4, s4, 1
    s_add_u32 s20, s20, s4
    s_lshr_b32 s5, s20, 7
    s_lshl_b32 s5, s5, 4
    s_bfe_u32 s6, s20, 0x40001
    s_add_u32 s5, s5, s6
    s_lshl_b32 s5, s5, 2
    s_bfe_u32 s6, s20, 0x20005
    s_add_u32 s5, s5, s6
    s_lshl_b32 s5, s5, 7
    s_add_u32 s5, s5, 26214400
    s_lshl_b32 s20, s20, 11
    s_add_u32 s20, s20, 41943040

    s_bitcmp1_b32 s2, 0
    s_cbranch_scc1 Lz_49
    buffer_load_dwordx2 v[120:121], v79, s[56:59], s5 offen sc1
Lz_49:
    s_lshr_b32 s3, s25, 6
    s_lshl_b32 s3, s3, 12
    s_bfe_u32 s4, s25, 0x10002
    s_lshl_b32 s4, s4, 11
    s_add_u32 s3, s3, s4
    s_and_b32 s4, s25, 3
    s_lshl_b32 s4, s4, 8
    s_add_u32 s3, s3, s4
    s_bfe_u32 s4, s25, 0x30003
    s_lshl_b32 s4, s4, 5
    s_add_u32 s3, s3, s4
    s_add_u32 s3, s3, 27262976
    s_lshl_b32 s4, s28, 20
    s_add_u32 s3, s3, s4

    s_bitcmp1_b32 s2, 0
    s_cbranch_scc1 Lz_50
    buffer_load_dwordx4 v[104:107], v76, s[56:59], s3 offen sc1
Lz_50:
    s_add_u32 s3, s3, 262144
    s_bitcmp1_b32 s2, 0
    s_cbranch_scc1 Lz_51
    buffer_load_dwordx4 v[108:111], v76, s[56:59], s3 offen sc1
Lz_51:
    s_add_u32 s3, s3, 262144
    s_bitcmp1_b32 s2, 0
    s_cbranch_scc1 Lz_52
    buffer_load_dwordx4 v[112:115], v76, s[56:59], s3 offen sc1
Lz_52:
    s_add_u32 s3, s3, 262144
    s_bitcmp1_b32 s2, 0
    s_cbranch_scc1 Lz_53
    buffer_load_dwordx4 v[116:119], v76, s[56:59], s3 offen sc1
Lz_53:
    s_add_u32 s3, s3, 262144
    s_lshr_b32 s21, s25, 3
    s_lshl_b32 s21, s21, 6
    s_and_b32 s4, s25, 7
    s_lshl_b32 s4, s4, 2
    s_add_u32 s21, s21, s4
    s_lshr_b32 s4, s28, 1
    s_lshl_b32 s4, s4, 5
    s_add_u32 s21, s21, s4
    s_and_b32 s4, s28, 1
    s_lshl_b32 s4, s4, 1
    s_add_u32 s21, s21, s4
    s_lshr_b32 s5, s21, 7
    s_lshl_b32 s5, s5, 4
    s_bfe_u32 s6, s21, 0x40001
    s_add_u32 s5, s5, s6
    s_lshl_b32 s5, s5, 2
    s_bfe_u32 s6, s21, 0x20005
    s_add_u32 s5, s5, s6
    s_lshl_b32 s5, s5, 7
    s_add_u32 s5, s5, 26214400
    s_lshl_b32 s21, s21, 11
    s_add_u32 s21, s21, 41943040

    s_bitcmp1_b32 s2, 0
    s_cbranch_scc1 Lz_54
    buffer_load_dwordx2 v[122:123], v79, s[56:59], s5 offen sc1
Lz_54:
    s_mov_b32 s60, s46
    s_mov_b32 s61, s47
    s_mov_b32 s62, 2048
    s_mov_b32 s63, 0x20000
    v_lshlrev_b32 v85, 6, v16
    v_lshl_add_u32 v85, v17, 4, v85
    s_bitcmp1_b32 s2, 0
    s_cbranch_scc1 Lz_55
    buffer_load_dwordx4 v[124:127], v85, s[60:63], 0 offen offset:0
Lz_55:
    s_bitcmp1_b32 s2, 0
    s_cbranch_scc1 Lz_56
    buffer_load_dwordx4 v[128:131], v85, s[60:63], 0 offen offset:1024
Lz_56:
    v_lshrrev_b32 v77, 2, v1
    s_lshl_b32 s6, s28, 6
    v_add_u32 v77, s6, v77
    v_sub_u32 v78, 512, v77
    v_and_b32 v79, 2, v1
    v_cmp_ne_u32 vcc, 0, v79
    s_nop 1
    v_cndmask_b32 v77, v77, v78, vcc
    v_mov_b32 v84, 64
    v_mov_b32 v78, -64
    v_cndmask_b32 v84, v84, v78, vcc
    v_lshlrev_b32 v77, 2, v77
    v_and_b32 v79, 1, v1
    v_lshlrev_b32 v79, 13, v79
    v_add_u32 v79, 0, v79
    v_add_u32 v81, v77, v79
    v_mov_b32 v78, 1024
    v_cmp_eq_u32 vcc, 2048, v77
    s_nop 1
    v_cndmask_b32 v78, v77, v78, vcc
    v_add_u32 v80, v78, v79
    v_add_u32 v81, v84, v81
    v_add_u32 v82, v84, v81
    v_add_u32 v83, v84, v82
    v_lshlrev_b32 v86, 9, v17
    v_lshl_add_u32 v86, v16, 2, v86
    s_lshl_b32 s6, s28, 12
    s_add_u32 s6, s6, 0
    v_add_u32 v86, s6, v86

    s_bitcmp1_b32 s2, 0
    s_cbranch_scc1 Lw1_57
    s_waitcnt vmcnt(12)
    s_branch Lw2_58
Lw1_57:
    s_waitcnt vmcnt(0)
Lw2_58:
    s_barrier
    s_bitcmp1_b32 s2, 0
    s_cbranch_scc1 Lw1_59
    s_waitcnt vmcnt(12)
    s_branch Lw2_60
Lw1_59:
    s_waitcnt vmcnt(0)
Lw2_60:
    s_barrier
    s_bitcmp1_b32 s2, 0
    s_cbranch_scc1 Lni_61
    s_waitcnt vmcnt(0)
    ds_write2st64_b32 v80, v88, v89 offset0:0 offset1:8
    ds_write2st64_b32 v80, v90, v91 offset0:16 offset1:24
    ds_write2st64_b32 v81, v92, v93 offset0:0 offset1:8
    ds_write2st64_b32 v81, v94, v95 offset0:16 offset1:24
    ds_write2st64_b32 v82, v96, v97 offset0:0 offset1:8
    ds_write2st64_b32 v82, v98, v99 offset0:16 offset1:24
    ds_write2st64_b32 v83, v100, v101 offset0:0 offset1:8
    ds_write2st64_b32 v83, v102, v103 offset0:16 offset1:24
    ds_write2st64_b32 v80, v104, v105 offset0:64 offset1:72
    ds_write2st64_b32 v80, v106, v107 offset0:80 offset1:88
    ds_write2st64_b32 v81, v108, v109 offset0:64 offset1:72
    ds_write2st64_b32 v81, v110, v111 offset0:80 offset1:88
    ds_write2st64_b32 v82, v112, v113 offset0:64 offset1:72
    ds_write2st64_b32 v82, v114, v115 offset0:80 offset1:88
    ds_write2st64_b32 v83, v116, v117 offset0:64 offset1:72
    ds_write2st64_b32 v83, v118, v119 offset0:80 offset1:88
    v_lshlrev_b32 v188, 16, v124
    v_and_b32 v189, 0xffff0000, v124
    v_lshlrev_b32 v190, 16, v125
    v_and_b32 v191, 0xffff0000, v125
    v_lshlrev_b32 v192, 16, v126
    v_and_b32 v193, 0xffff0000, v126
    v_lshlrev_b32 v194, 16, v127
    v_and_b32 v195, 0xffff0000, v127
    v_lshlrev_b32 v196, 16, v128
    v_and_b32 v197, 0xffff0000, v128
    v_lshlrev_b32 v198, 16, v129
    v_and_b32 v199, 0xffff0000, v129
    v_lshlrev_b32 v200, 16, v130
    v_and_b32 v201, 0xffff0000, v130
    v_lshlrev_b32 v202, 16, v131
    v_and_b32 v203, 0xffff0000, v131
    s_waitcnt lgkmcnt(0)
    v_mov_b32 v13, 98356
    v_mov_b32 v14, 1
    s_mov_b64 exec, 1
    ds_add_u32 v13, v14
Lcb_62:
    ds_read_b32 v14, v13
    s_waitcnt lgkmcnt(0)
    v_readfirstlane_b32 s7, v14
    s_nop 0
    s_cmp_ge_u32 s7, 4
    s_cbranch_scc0 Lcb_62
    s_mov_b64 exec, -1
    v_add_u32 v87, 0, v86
    ds_read2_b32 v[88:89], v87 offset0:0 offset1:32
    ds_read2_b32 v[90:91], v87 offset0:64 offset1:96
    ds_read2_b32 v[92:93], v87 offset0:16 offset1:48
    ds_read2_b32 v[94:95], v87 offset0:80 offset1:112
    v_add_u32 v87, 2048, v86
    ds_read2_b32 v[96:97], v87 offset0:0 offset1:32
    ds_read2_b32 v[98:99], v87 offset0:64 offset1:96
    ds_read2_b32 v[100:101], v87 offset0:16 offset1:48
    ds_read2_b32 v[102:103], v87 offset0:80 offset1:112
    v_add_u32 v87, 16384, v86
    ds_read2_b32 v[104:105], v87 offset0:0 offset1:32
    ds_read2_b32 v[106:107], v87 offset0:64 offset1:96
    ds_read2_b32 v[108:109], v87 offset0:16 offset1:48
    ds_read2_b32 v[110:111], v87 offset0:80 offset1:112
    v_add_u32 v87, 18432, v86
    ds_read2_b32 v[112:113], v87 offset0:0 offset1:32
    ds_read2_b32 v[114:115], v87 offset0:64 offset1:96
    ds_read2_b32 v[116:117], v87 offset0:16 offset1:48
    ds_read2_b32 v[118:119], v87 offset0:80 offset1:112
    v_sub_f32 v204, 1.0, v120
    v_sub_f32 v205, 1.0, v121
    v_cvt_pk_bf16_f32 v78, v204, v205
    v_lshlrev_b32 v204, 16, v78
    v_and_b32 v205, 0xffff0000, v78
    s_waitcnt lgkmcnt(12)
    v_mfma_f32_16x16x32_bf16 v[132:135], v[88:91], v[20:23], 0
    v_mfma_f32_16x16x32_bf16 v[136:139], v[88:91], v[24:27], 0
    v_mfma_f32_16x16x32_bf16 v[140:143], v[92:95], v[20:23], 0
    v_mfma_f32_16x16x32_bf16 v[144:147], v[92:95], v[24:27], 0
    s_nop 4
    v_mul_f32 v172, v132, v28
    v_mul_f32 v173, v136, v28
    v_mul_f32 v174, v133, v30
    v_mul_f32 v175, v137, v30
    v_mul_f32 v176, v134, v32
    v_mul_f32 v177, v138, v32
    v_mul_f32 v178, v135, v34
    v_mul_f32 v179, v139, v34
    v_fmac_f32 v172, v136, v29
    v_fma_f32 v173, -v132, v29, v173
    v_fmac_f32 v174, v137, v31
    v_fma_f32 v175, -v133, v31, v175
    v_fmac_f32 v176, v138, v33
    v_fma_f32 v177, -v134, v33, v177
    v_fmac_f32 v178, v139, v35
    v_fma_f32 v179, -v135, v35, v179
    v_cvt_pk_bf16_f32 v148, v172, v173
    v_cvt_pk_bf16_f32 v149, v174, v175
    v_cvt_pk_bf16_f32 v150, v176, v177
    v_cvt_pk_bf16_f32 v151, v178, v179
    v_mul_f32 v172, v140, v36
    v_mul_f32 v173, v144, v36
    v_mul_f32 v174, v141, v38
    v_mul_f32 v175, v145, v38
    v_mul_f32 v176, v142, v40
    v_mul_f32 v177, v146, v40
    v_mul_f32 v178, v143, v42
    v_mul_f32 v179, v147, v42
    v_fmac_f32 v172, v144, v37
    v_fma_f32 v173, -v140, v37, v173
    v_fmac_f32 v174, v145, v39
    v_fma_f32 v175, -v141, v39, v175
    v_fmac_f32 v176, v146, v41
    v_fma_f32 v177, -v142, v41, v177
    v_fmac_f32 v178, v147, v43
    v_fma_f32 v179, -v143, v43, v179
    v_cvt_pk_bf16_f32 v152, v172, v173
    v_cvt_pk_bf16_f32 v153, v174, v175
    v_cvt_pk_bf16_f32 v154, v176, v177
    v_cvt_pk_bf16_f32 v155, v178, v179
    v_mfma_f32_16x16x32_bf16 v[156:159], v[148:151], v[44:47], 0
    v_mfma_f32_16x16x32_bf16 v[160:163], v[148:151], v[48:51], 0
    v_mfma_f32_16x16x32_bf16 v[164:167], v[148:151], v[60:63], 0
    v_mfma_f32_16x16x32_bf16 v[168:171], v[148:151], v[64:67], 0
    v_mfma_f32_16x16x32_bf16 v[156:159], v[152:155], v[52:55], v[156:159]
    v_mfma_f32_16x16x32_bf16 v[160:163], v[152:155], v[56:59], v[160:163]
    v_mfma_f32_16x16x32_bf16 v[164:167], v[152:155], v[68:71], v[164:167]
    v_mfma_f32_16x16x32_bf16 v[168:171], v[152:155], v[72:75], v[168:171]
    v_mul_f32 v172, v204, v188
    v_mul_f32 v173, v204, v189
    v_mul_f32 v174, v204, v190
    v_mul_f32 v175, v204, v191
    v_mul_f32 v176, v204, v192
    v_mul_f32 v177, v204, v193
    v_mul_f32 v178, v204, v194
    v_mul_f32 v179, v204, v195
    v_fmac_f32 v172, v120, v156
    v_fmac_f32 v173, v120, v160
    v_fmac_f32 v174, v120, v157
    v_fmac_f32 v175, v120, v161
    v_fmac_f32 v176, v120, v158
    v_fmac_f32 v177, v120, v162
    v_fmac_f32 v178, v120, v159
    v_fmac_f32 v179, v120, v163
    v_cvt_pk_bf16_f32 v208, v172, v173
    v_cvt_pk_bf16_f32 v209, v174, v175
    v_cvt_pk_bf16_f32 v210, v176, v177
    v_cvt_pk_bf16_f32 v211, v178, v179
    buffer_store_dwordx4 v[208:211], v85, s[56:59], s20 offen offset:0 sc1
    v_mul_f32 v172, v204, v196
    v_mul_f32 v173, v204, v197
    v_mul_f32 v174, v204, v198
    v_mul_f32 v175, v204, v199
    v_mul_f32 v176, v204, v200
    v_mul_f32 v177, v204, v201
    v_mul_f32 v178, v204, v202
    v_mul_f32 v179, v204, v203
    v_fmac_f32 v172, v120, v164
    v_fmac_f32 v173, v120, v168
    v_fmac_f32 v174, v120, v165
    v_fmac_f32 v175, v120, v169
    v_fmac_f32 v176, v120, v166
    v_fmac_f32 v177, v120, v170
    v_fmac_f32 v178, v120, v167
    v_fmac_f32 v179, v120, v171
    v_cvt_pk_bf16_f32 v212, v172, v173
    v_cvt_pk_bf16_f32 v213, v174, v175
    v_cvt_pk_bf16_f32 v214, v176, v177
    v_cvt_pk_bf16_f32 v215, v178, v179
    buffer_store_dwordx4 v[212:215], v85, s[56:59], s20 offen offset:1024 sc1
    s_waitcnt lgkmcnt(8)
    v_mfma_f32_16x16x32_bf16 v[132:135], v[96:99], v[20:23], 0
    v_mfma_f32_16x16x32_bf16 v[136:139], v[96:99], v[24:27], 0
    v_mfma_f32_16x16x32_bf16 v[140:143], v[100:103], v[20:23], 0
    v_mfma_f32_16x16x32_bf16 v[144:147], v[100:103], v[24:27], 0
    s_nop 4
    v_mul_f32 v172, v132, v28
    v_mul_f32 v173, v136, v28
    v_mul_f32 v174, v133, v30
    v_mul_f32 v175, v137, v30
    v_mul_f32 v176, v134, v32
    v_mul_f32 v177, v138, v32
    v_mul_f32 v178, v135, v34
    v_mul_f32 v179, v139, v34
    v_fmac_f32 v172, v136, v29
    v_fma_f32 v173, -v132, v29, v173
    v_fmac_f32 v174, v137, v31
    v_fma_f32 v175, -v133, v31, v175
    v_fmac_f32 v176, v138, v33
    v_fma_f32 v177, -v134, v33, v177
    v_fmac_f32 v178, v139, v35
    v_fma_f32 v179, -v135, v35, v179
    v_cvt_pk_bf16_f32 v148, v172, v173
    v_cvt_pk_bf16_f32 v149, v174, v175
    v_cvt_pk_bf16_f32 v150, v176, v177
    v_cvt_pk_bf16_f32 v151, v178, v179
    v_mul_f32 v172, v140, v36
    v_mul_f32 v173, v144, v36
    v_mul_f32 v174, v141, v38
    v_mul_f32 v175, v145, v38
    v_mul_f32 v176, v142, v40
    v_mul_f32 v177, v146, v40
    v_mul_f32 v178, v143, v42
    v_mul_f32 v179, v147, v42
    v_fmac_f32 v172, v144, v37
    v_fma_f32 v173, -v140, v37, v173
    v_fmac_f32 v174, v145, v39
    v_fma_f32 v175, -v141, v39, v175
    v_fmac_f32 v176, v146, v41
    v_fma_f32 v177, -v142, v41, v177
    v_fmac_f32 v178, v147, v43
    v_fma_f32 v179, -v143, v43, v179
    v_cvt_pk_bf16_f32 v152, v172, v173
    v_cvt_pk_bf16_f32 v153, v174, v175
    v_cvt_pk_bf16_f32 v154, v176, v177
    v_cvt_pk_bf16_f32 v155, v178, v179
    v_mfma_f32_16x16x32_bf16 v[156:159], v[148:151], v[44:47], 0
    v_mfma_f32_16x16x32_bf16 v[160:163], v[148:151], v[48:51], 0
    v_mfma_f32_16x16x32_bf16 v[164:167], v[148:151], v[60:63], 0
    v_mfma_f32_16x16x32_bf16 v[168:171], v[148:151], v[64:67], 0
    v_mfma_f32_16x16x32_bf16 v[156:159], v[152:155], v[52:55], v[156:159]
    v_mfma_f32_16x16x32_bf16 v[160:163], v[152:155], v[56:59], v[160:163]
    v_mfma_f32_16x16x32_bf16 v[164:167], v[152:155], v[68:71], v[164:167]
    v_mfma_f32_16x16x32_bf16 v[168:171], v[152:155], v[72:75], v[168:171]
    v_mul_f32 v172, v205, v188
    v_mul_f32 v173, v205, v189
    v_mul_f32 v174, v205, v190
    v_mul_f32 v175, v205, v191
    v_mul_f32 v176, v205, v192
    v_mul_f32 v177, v205, v193
    v_mul_f32 v178, v205, v194
    v_mul_f32 v179, v205, v195
    v_fmac_f32 v172, v121, v156
    v_fmac_f32 v173, v121, v160
    v_fmac_f32 v174, v121, v157
    v_fmac_f32 v175, v121, v161
    v_fmac_f32 v176, v121, v158
    v_fmac_f32 v177, v121, v162
    v_fmac_f32 v178, v121, v159
    v_fmac_f32 v179, v121, v163
    v_cvt_pk_bf16_f32 v216, v172, v173
    v_cvt_pk_bf16_f32 v217, v174, v175
    v_cvt_pk_bf16_f32 v218, v176, v177
    v_cvt_pk_bf16_f32 v219, v178, v179
    buffer_store_dwordx4 v[216:219], v85, s[56:59], s20 offen offset:2048 sc1
    v_mul_f32 v172, v205, v196
    v_mul_f32 v173, v205, v197
    v_mul_f32 v174, v205, v198
    v_mul_f32 v175, v205, v199
    v_mul_f32 v176, v205, v200
    v_mul_f32 v177, v205, v201
    v_mul_f32 v178, v205, v202
    v_mul_f32 v179, v205, v203
    v_fmac_f32 v172, v121, v164
    v_fmac_f32 v173, v121, v168
    v_fmac_f32 v174, v121, v165
    v_fmac_f32 v175, v121, v169
    v_fmac_f32 v176, v121, v166
    v_fmac_f32 v177, v121, v170
    v_fmac_f32 v178, v121, v167
    v_fmac_f32 v179, v121, v171
    v_cvt_pk_bf16_f32 v220, v172, v173
    v_cvt_pk_bf16_f32 v221, v174, v175
    v_cvt_pk_bf16_f32 v222, v176, v177
    v_cvt_pk_bf16_f32 v223, v178, v179
    buffer_store_dwordx4 v[220:223], v85, s[56:59], s20 offen offset:3072 sc1
    v_sub_f32 v204, 1.0, v122
    v_sub_f32 v205, 1.0, v123
    v_cvt_pk_bf16_f32 v78, v204, v205
    v_lshlrev_b32 v204, 16, v78
    v_and_b32 v205, 0xffff0000, v78
    s_waitcnt lgkmcnt(4)
    v_mfma_f32_16x16x32_bf16 v[132:135], v[104:107], v[20:23], 0
    v_mfma_f32_16x16x32_bf16 v[136:139], v[104:107], v[24:27], 0
    v_mfma_f32_16x16x32_bf16 v[140:143], v[108:111], v[20:23], 0
    v_mfma_f32_16x16x32_bf16 v[144:147], v[108:111], v[24:27], 0
    s_nop 4
    v_mul_f32 v172, v132, v28
    v_mul_f32 v173, v136, v28
    v_mul_f32 v174, v133, v30
    v_mul_f32 v175, v137, v30
    v_mul_f32 v176, v134, v32
    v_mul_f32 v177, v138, v32
    v_mul_f32 v178, v135, v34
    v_mul_f32 v179, v139, v34
    v_fmac_f32 v172, v136, v29
    v_fma_f32 v173, -v132, v29, v173
    v_fmac_f32 v174, v137, v31
    v_fma_f32 v175, -v133, v31, v175
    v_fmac_f32 v176, v138, v33
    v_fma_f32 v177, -v134, v33, v177
    v_fmac_f32 v178, v139, v35
    v_fma_f32 v179, -v135, v35, v179
    v_cvt_pk_bf16_f32 v148, v172, v173
    v_cvt_pk_bf16_f32 v149, v174, v175
    v_cvt_pk_bf16_f32 v150, v176, v177
    v_cvt_pk_bf16_f32 v151, v178, v179
    v_mul_f32 v172, v140, v36
    v_mul_f32 v173, v144, v36
    v_mul_f32 v174, v141, v38
    v_mul_f32 v175, v145, v38
    v_mul_f32 v176, v142, v40
    v_mul_f32 v177, v146, v40
    v_mul_f32 v178, v143, v42
    v_mul_f32 v179, v147, v42
    v_fmac_f32 v172, v144, v37
    v_fma_f32 v173, -v140, v37, v173
    v_fmac_f32 v174, v145, v39
    v_fma_f32 v175, -v141, v39, v175
    v_fmac_f32 v176, v146, v41
    v_fma_f32 v177, -v142, v41, v177
    v_fmac_f32 v178, v147, v43
    v_fma_f32 v179, -v143, v43, v179
    v_cvt_pk_bf16_f32 v152, v172, v173
    v_cvt_pk_bf16_f32 v153, v174, v175
    v_cvt_pk_bf16_f32 v154, v176, v177
    v_cvt_pk_bf16_f32 v155, v178, v179
    v_mfma_f32_16x16x32_bf16 v[156:159], v[148:151], v[44:47], 0
    v_mfma_f32_16x16x32_bf16 v[160:163], v[148:151], v[48:51], 0
    v_mfma_f32_16x16x32_bf16 v[164:167], v[148:151], v[60:63], 0
    v_mfma_f32_16x16x32_bf16 v[168:171], v[148:151], v[64:67], 0
    v_mfma_f32_16x16x32_bf16 v[156:159], v[152:155], v[52:55], v[156:159]
    v_mfma_f32_16x16x32_bf16 v[160:163], v[152:155], v[56:59], v[160:163]
    v_mfma_f32_16x16x32_bf16 v[164:167], v[152:155], v[68:71], v[164:167]
    v_mfma_f32_16x16x32_bf16 v[168:171], v[152:155], v[72:75], v[168:171]
    v_mul_f32 v172, v204, v188
    v_mul_f32 v173, v204, v189
    v_mul_f32 v174, v204, v190
    v_mul_f32 v175, v204, v191
    v_mul_f32 v176, v204, v192
    v_mul_f32 v177, v204, v193
    v_mul_f32 v178, v204, v194
    v_mul_f32 v179, v204, v195
    v_fmac_f32 v172, v122, v156
    v_fmac_f32 v173, v122, v160
    v_fmac_f32 v174, v122, v157
    v_fmac_f32 v175, v122, v161
    v_fmac_f32 v176, v122, v158
    v_fmac_f32 v177, v122, v162
    v_fmac_f32 v178, v122, v159
    v_fmac_f32 v179, v122, v163
    v_cvt_pk_bf16_f32 v208, v172, v173
    v_cvt_pk_bf16_f32 v209, v174, v175
    v_cvt_pk_bf16_f32 v210, v176, v177
    v_cvt_pk_bf16_f32 v211, v178, v179
    buffer_store_dwordx4 v[208:211], v85, s[56:59], s21 offen offset:0 sc1
    v_mul_f32 v172, v204, v196
    v_mul_f32 v173, v204, v197
    v_mul_f32 v174, v204, v198
    v_mul_f32 v175, v204, v199
    v_mul_f32 v176, v204, v200
    v_mul_f32 v177, v204, v201
    v_mul_f32 v178, v204, v202
    v_mul_f32 v179, v204, v203
    v_fmac_f32 v172, v122, v164
    v_fmac_f32 v173, v122, v168
    v_fmac_f32 v174, v122, v165
    v_fmac_f32 v175, v122, v169
    v_fmac_f32 v176, v122, v166
    v_fmac_f32 v177, v122, v170
    v_fmac_f32 v178, v122, v167
    v_fmac_f32 v179, v122, v171
    v_cvt_pk_bf16_f32 v212, v172, v173
    v_cvt_pk_bf16_f32 v213, v174, v175
    v_cvt_pk_bf16_f32 v214, v176, v177
    v_cvt_pk_bf16_f32 v215, v178, v179
    buffer_store_dwordx4 v[212:215], v85, s[56:59], s21 offen offset:1024 sc1
    s_waitcnt lgkmcnt(0)
    v_mfma_f32_16x16x32_bf16 v[132:135], v[112:115], v[20:23], 0
    v_mfma_f32_16x16x32_bf16 v[136:139], v[112:115], v[24:27], 0
    v_mfma_f32_16x16x32_bf16 v[140:143], v[116:119], v[20:23], 0
    v_mfma_f32_16x16x32_bf16 v[144:147], v[116:119], v[24:27], 0
    s_nop 4
    v_mul_f32 v172, v132, v28
    v_mul_f32 v173, v136, v28
    v_mul_f32 v174, v133, v30
    v_mul_f32 v175, v137, v30
    v_mul_f32 v176, v134, v32
    v_mul_f32 v177, v138, v32
    v_mul_f32 v178, v135, v34
    v_mul_f32 v179, v139, v34
    v_fmac_f32 v172, v136, v29
    v_fma_f32 v173, -v132, v29, v173
    v_fmac_f32 v174, v137, v31
    v_fma_f32 v175, -v133, v31, v175
    v_fmac_f32 v176, v138, v33
    v_fma_f32 v177, -v134, v33, v177
    v_fmac_f32 v178, v139, v35
    v_fma_f32 v179, -v135, v35, v179
    v_cvt_pk_bf16_f32 v148, v172, v173
    v_cvt_pk_bf16_f32 v149, v174, v175
    v_cvt_pk_bf16_f32 v150, v176, v177
    v_cvt_pk_bf16_f32 v151, v178, v179
    v_mul_f32 v172, v140, v36
    v_mul_f32 v173, v144, v36
    v_mul_f32 v174, v141, v38
    v_mul_f32 v175, v145, v38
    v_mul_f32 v176, v142, v40
    v_mul_f32 v177, v146, v40
    v_mul_f32 v178, v143, v42
    v_mul_f32 v179, v147, v42
    v_fmac_f32 v172, v144, v37
    v_fma_f32 v173, -v140, v37, v173
    v_fmac_f32 v174, v145, v39
    v_fma_f32 v175, -v141, v39, v175
    v_fmac_f32 v176, v146, v41
    v_fma_f32 v177, -v142, v41, v177
    v_fmac_f32 v178, v147, v43
    v_fma_f32 v179, -v143, v43, v179
    v_cvt_pk_bf16_f32 v152, v172, v173
    v_cvt_pk_bf16_f32 v153, v174, v175
    v_cvt_pk_bf16_f32 v154, v176, v177
    v_cvt_pk_bf16_f32 v155, v178, v179
    v_mfma_f32_16x16x32_bf16 v[156:159], v[148:151], v[44:47], 0
    v_mfma_f32_16x16x32_bf16 v[160:163], v[148:151], v[48:51], 0
    v_mfma_f32_16x16x32_bf16 v[164:167], v[148:151], v[60:63], 0
    v_mfma_f32_16x16x32_bf16 v[168:171], v[148:151], v[64:67], 0
    v_mfma_f32_16x16x32_bf16 v[156:159], v[152:155], v[52:55], v[156:159]
    v_mfma_f32_16x16x32_bf16 v[160:163], v[152:155], v[56:59], v[160:163]
    v_mfma_f32_16x16x32_bf16 v[164:167], v[152:155], v[68:71], v[164:167]
    v_mfma_f32_16x16x32_bf16 v[168:171], v[152:155], v[72:75], v[168:171]
    v_mul_f32 v172, v205, v188
    v_mul_f32 v173, v205, v189
    v_mul_f32 v174, v205, v190
    v_mul_f32 v175, v205, v191
    v_mul_f32 v176, v205, v192
    v_mul_f32 v177, v205, v193
    v_mul_f32 v178, v205, v194
    v_mul_f32 v179, v205, v195
    v_fmac_f32 v172, v123, v156
    v_fmac_f32 v173, v123, v160
    v_fmac_f32 v174, v123, v157
    v_fmac_f32 v175, v123, v161
    v_fmac_f32 v176, v123, v158
    v_fmac_f32 v177, v123, v162
    v_fmac_f32 v178, v123, v159
    v_fmac_f32 v179, v123, v163
    v_cvt_pk_bf16_f32 v216, v172, v173
    v_cvt_pk_bf16_f32 v217, v174, v175
    v_cvt_pk_bf16_f32 v218, v176, v177
    v_cvt_pk_bf16_f32 v219, v178, v179
    buffer_store_dwordx4 v[216:219], v85, s[56:59], s21 offen offset:2048 sc1
    v_mul_f32 v172, v205, v196
    v_mul_f32 v173, v205, v197
    v_mul_f32 v174, v205, v198
    v_mul_f32 v175, v205, v199
    v_mul_f32 v176, v205, v200
    v_mul_f32 v177, v205, v201
    v_mul_f32 v178, v205, v202
    v_mul_f32 v179, v205, v203
    v_fmac_f32 v172, v123, v164
    v_fmac_f32 v173, v123, v168
    v_fmac_f32 v174, v123, v165
    v_fmac_f32 v175, v123, v169
    v_fmac_f32 v176, v123, v166
    v_fmac_f32 v177, v123, v170
    v_fmac_f32 v178, v123, v167
    v_fmac_f32 v179, v123, v171
    v_cvt_pk_bf16_f32 v220, v172, v173
    v_cvt_pk_bf16_f32 v221, v174, v175
    v_cvt_pk_bf16_f32 v222, v176, v177
    v_cvt_pk_bf16_f32 v223, v178, v179
    buffer_store_dwordx4 v[220:223], v85, s[56:59], s21 offen offset:3072 sc1
    s_waitcnt vmcnt(0)
    v_mov_b32 v13, 98320
    v_mov_b32 v14, 1
    s_mov_b64 exec, 1
    ds_add_rtn_u32 v14, v13, v14
    s_waitcnt lgkmcnt(0)
    v_readfirstlane_b32 s7, v14
    s_nop 0
    s_cmp_eq_u32 s7, 3
    s_cbranch_scc0 Lsg_63
    v_mov_b32 v13, 4
    v_mov_b32 v14, 1
    global_atomic_add v15, v13, v14, s[52:53] sc0 sc1
    s_waitcnt vmcnt(0)
    v_readfirstlane_b32 s7, v15
    s_nop 0
    s_cmp_eq_u32 s7, 127
    s_cbranch_scc0 Lar_64
    global_store_dword v13, v14, s[52:53] offset:132 sc1
Lar_64:
Lsg_63:
    s_mov_b64 exec, -1
Lni_61:
    s_cmp_lg_u32 s28, 0
    s_cbranch_scc1 Lnp_65
    v_mov_b32 v13, 136
    s_mov_b32 s78, 0
Lpd_66:
    global_load_dword v14, v13, s[52:53] sc1
    s_waitcnt vmcnt(0)
    v_readfirstlane_b32 s79, v14
    s_nop 0
    s_cmp_ge_u32 s79, 1
    s_cbranch_scc1 Lpo_67
    s_sleep 2
    s_add_u32 s78, s78, 1
    s_cmp_lt_u32 s78, 262144
    s_cbranch_scc1 Lpd_66
Lpo_67:
    v_mov_b32 v13, 98312
    v_mov_b32 v14, 1
    ds_write_b32 v13, v14
Lnp_65:
Lend_1:
    s_endpgm
.section .rodata,"a"
.p2align 6
.amdhsa_kernel gated_mix__spectral_gfnet__dense_activation_gelu__prompt_kernel
  .amdhsa_next_free_vgpr 256
  .amdhsa_next_free_sgpr 102
  .amdhsa_accum_offset 256
  .amdhsa_group_segment_fixed_size 0
  .amdhsa_kernarg_size 96
  .amdhsa_user_sgpr_count 2
  .amdhsa_user_sgpr_kernarg_segment_ptr 1
  .amdhsa_system_sgpr_workgroup_id_x 1
  .amdhsa_float_denorm_mode_32 3
.end_amdhsa_kernel
```
